```python
import torch

def _softmax(x, axis=-1):
    return torch.softmax(x, dim=axis)

def _gelu(x):
    return torch.nn.functional.gelu(x, approximate='tanh')

def _silu(x):
    return torch.nn.functional.silu(x)

def _sigmoid(x):
    return torch.sigmoid(x)

def _layernorm(x, axis=-1, eps=1e-05):
    m = x.mean(dim=axis, keepdim=True)
    v = x.var(dim=axis, keepdim=True, unbiased=False)
    return (x - m) / torch.sqrt(v + eps)

def _scatter_add(tgt, idx, src, axis=0):
    return tgt.clone().index_add_(axis, idx, src)

def _segment_sum(src, seg, n):
    out = torch.zeros((n,) + src.shape[1:], dtype=src.dtype)
    return out.index_add_(0, seg, src)

def _pad(x, pw):
    flat = tuple((v for pair in reversed(pw) for v in pair))
    return torch.nn.functional.pad(x, flat)
kernel_name = 'adaLN_cond__sliding_block_cached__mixer_channel_mlp__decode'

def setup_inputs():

    _w = lambda a: (lambda t: t.to(torch.bfloat16) if t.is_floating_point() else t)(torch.as_tensor(a))

    def _A_setup():
        B, Sq, D = (2, 1, 512)
        Hq, Hkv, Sk, Dh = (32, 8, 8192, 128)
        assert Hq % Hkv == 0, (Hq, Hkv)
        return {'x': _w((lambda *s: torch.randn(*s, dtype=torch.bfloat16) * 0.1)(B, Sq, D)), 'k_cache': _w((lambda *s: torch.randn(*s, dtype=torch.bfloat16) * 0.8)(B, Hkv, Sk, Dh)), 'v_cache': _w((lambda *s: torch.randn(*s, dtype=torch.bfloat16) * 0.8)(B, Hkv, Sk, Dh)), 'wq': _w((lambda *s: torch.randn(*s, dtype=torch.bfloat16) * 0.8)(D, Hq * Dh) * D ** (-0.5)), 'wo': _w((lambda *s: torch.randn(*s, dtype=torch.bfloat16) * 0.8)(Hq * Dh, D) * (Hq * Dh) ** (-0.5))}
    _A_in = _A_setup()

    def _B_setup():
        B, S, D, F = (2, 1, 512, 1792)
        return {'x': _w((lambda *s: torch.randn(*s, dtype=torch.bfloat16) * 0.1)(B, S, D)), 'w1': _w((lambda *s: torch.randn(*s, dtype=torch.bfloat16) * 3.2)(D, F) * D ** (-0.5)), 'b1': _w((lambda *s: torch.randn(*s, dtype=torch.bfloat16) * 3.2)(F)), 'w2': _w((lambda *s: torch.randn(*s, dtype=torch.bfloat16) * 3.2)(F, D) * F ** (-0.5)), 'b2': _w((lambda *s: torch.randn(*s, dtype=torch.bfloat16) * 3.2)(D))}
    _B_in = _B_setup()
    return {'A_x': _A_in['x'], 'A_k_cache': _A_in['k_cache'], 'A_v_cache': _A_in['v_cache'], 'A_wq': _A_in['wq'], 'A_wo': _A_in['wo'], 'B_x': _B_in['x'], 'B_w1': _B_in['w1'], 'B_b1': _B_in['b1'], 'B_w2': _B_in['w2'], 'B_b2': _B_in['b2'], 'c': _w((lambda *s: torch.randn(*s, dtype=torch.bfloat16) * 0.4)(2, 512) * 8.0), 'w_mod': _w((lambda *s: torch.randn(*s, dtype=torch.bfloat16) * 0.4)(512, 6 * 512) * 512 ** (-0.5) * 8.0)}

def reference(A_x, A_k_cache, A_v_cache, A_wq, A_wo, B_x, B_w1, B_b1, B_w2, B_b2, c, w_mod):

    def _A_ref(x, k_cache, v_cache, wq, wo):
        B, Sq, D = x.shape
        Hq, Dh = (32, 128)
        Hkv, Sk = (k_cache.shape[1], k_cache.shape[2])
        W = min(4096, max(256, Sk // 4))
        rep = Hq // Hkv
        q = (lambda x, *d: x.permute(*d))((x @ wq).reshape(B, Sq, Hq, Dh), 0, 2, 1, 3)
        k = (lambda x, n, axis: torch.repeat_interleave(x, n, dim=axis))(k_cache[:, :, Sk - W:, :], rep, axis=1)
        v = (lambda x, n, axis: torch.repeat_interleave(x, n, dim=axis))(v_cache[:, :, Sk - W:, :], rep, axis=1)
        scores = torch.einsum('bhqd,bhkd->bhqk', q, k) * Dh ** (-0.5)
        p = _softmax(scores, axis=-1)
        o = torch.einsum('bhqk,bhkd->bhqd', p, v)
        return (lambda x, *d: x.permute(*d))(o, 0, 2, 1, 3).reshape(B, Sq, Hq * Dh) @ wo

    def _B_ref(x, w1, b1, w2, b2):
        y = _layernorm(x, axis=-1)
        h = _gelu(torch.einsum('bsd,df->bsf', y, w1) + b1)
        return torch.einsum('bsf,fd->bsd', h, w2) + b2
    x = A_x
    mod = (_silu(c) @ w_mod).reshape(c.shape[0], 6, 1, -1)
    sa, ca, ga, sb, cb, gb = (mod[:, 0].clone(), mod[:, 1].clone(), mod[:, 2].clone(), mod[:, 3].clone(), mod[:, 4].clone(), mod[:, 5].clone())
    h = _layernorm(x, axis=-1) * (1 + ca) + sa
    x = x + ga * _A_ref(h, A_k_cache, A_v_cache, A_wq, A_wo)
    h = _layernorm(x, axis=-1) * (1 + cb) + sb
    x = x + gb * _B_ref(h, B_w1, B_b1, B_w2, B_b2)
    return x
```

```asm
; @launch grid=(256,1,1) block=(576,1,1) lds=151552
.amdgcn_target "amdgcn-amd-amdhsa--gfx950"
.text
.globl adaLN_cond__sliding_block_cached__mixer_channel_mlp__decode_kernel
.p2align 8
.type adaLN_cond__sliding_block_cached__mixer_channel_mlp__decode_kernel,@function
adaLN_cond__sliding_block_cached__mixer_channel_mlp__decode_kernel:
    s_load_dwordx2 s[30:31], s[0:1], 112
    s_load_dwordx16 s[4:19], s[0:1], 0
    s_load_dwordx8 s[20:27], s[0:1], 64
    s_load_dwordx2 s[28:29], s[0:1], 96
    v_readfirstlane_b32 s34, v0
    s_lshr_b32 s33, s2, 3
    s_cmp_ge_u32 s33, 32
    s_cbranch_scc1 L_EXIT
    s_and_b32 s32, s2, 7
    v_and_b32 v0, 63, v0
    v_and_b32 v1, 15, v0
    v_lshrrev_b32 v2, 4, v0
    s_lshr_b32 s34, s34, 6
    s_sub_u32 s34, s34, 1
    s_cbranch_scc1 L_HELP
    s_cmp_ge_u32 s33, 16
    s_cbranch_scc1 L_W
L_T:
    s_and_b32 s46, s33, 8
    s_add_u32 s46, s46, s32
    s_lshl_b32 s46, s46, 5
    s_or_b32 s47, s33, 24
    s_or_b32 s46, s46, s47
    s_lshl_b32 s46, s46, 16
    s_add_u32 s47, s34, s33
    s_add_u32 s47, s47, s32
    s_and_b32 s47, s47, 7
    s_lshl3_add_u32 s48, s34, s47
    s_lshl_b32 s48, s48, 10
    s_and_b32 s47, s47, 1
    s_lshl_b32 s47, s47, 7
    s_or_b32 s47, s47, s48
    s_mov_b32 m0, s48
    v_lshlrev_b32 v3, 1, v2
    v_xor_b32 v3, v3, v0
    v_lshlrev_b32 v3, 4, v3
    v_xor_b32 v8, s47, v3
    s_waitcnt lgkmcnt(0)
    s_add_u32 s6, s6, s46
    s_addc_u32 s7, s7, 0
    global_load_lds_dwordx4 v8, s[6:7] nt
    s_xor_b32 m0, s48, 4096
    v_xor_b32 v9, 4096, v8
    global_load_lds_dwordx4 v9, s[6:7] nt
    s_xor_b32 m0, s48, 1024
    v_xor_b32 v10, 1152, v8
    global_load_lds_dwordx4 v10, s[6:7] nt
    s_xor_b32 m0, s48, 5120
    v_xor_b32 v11, 5248, v8
    global_load_lds_dwordx4 v11, s[6:7] nt
    s_load_dword s35, s[30:31], 0
    s_add_u32 s8, s8, s46
    s_addc_u32 s9, s9, 0
    s_add_u32 s49, s48, 65536
    s_lshl_b32 s62, s32, 16
    s_and_b32 s44, s33, 15
    s_getreg_b32 s37, hwreg(HW_REG_XCC_ID, 0, 4)
    v_mov_b32 v29, 132352
    s_xor_b32 m0, s48, 2048
    v_xor_b32 v12, 2048, v8
    s_waitcnt vmcnt(3)
    global_load_lds_dwordx4 v12, s[6:7] nt
    s_xor_b32 m0, s48, 6144
    v_xor_b32 v13, 6144, v8
    s_waitcnt vmcnt(3)
    global_load_lds_dwordx4 v13, s[6:7] nt
    s_xor_b32 m0, s48, 3072
    v_xor_b32 v14, 3200, v8
    s_waitcnt vmcnt(3)
    global_load_lds_dwordx4 v14, s[6:7] nt
    s_xor_b32 m0, s48, 7168
    v_xor_b32 v15, 7296, v8
    s_waitcnt vmcnt(3)
    global_load_lds_dwordx4 v15, s[6:7] nt
    s_xor_b32 m0, s49, 0
    s_waitcnt vmcnt(3)
    global_load_lds_dwordx4 v8, s[8:9] nt
    s_xor_b32 m0, s49, 4096
    s_waitcnt vmcnt(3)
    global_load_lds_dwordx4 v9, s[8:9] nt
    s_xor_b32 m0, s49, 1024
    s_waitcnt vmcnt(3)
    global_load_lds_dwordx4 v10, s[8:9] nt
    s_xor_b32 m0, s49, 5120
    s_waitcnt vmcnt(3)
    global_load_lds_dwordx4 v11, s[8:9] nt
    s_xor_b32 m0, s49, 2048
    s_waitcnt vmcnt(3)
    global_load_lds_dwordx4 v12, s[8:9] nt
    s_cmp_lg_u32 s34, 7
    s_cbranch_scc1 L_NOMARK
    ds_write_b32 v29, v29 offset:4
L_NOMARK:
    s_xor_b32 m0, s49, 6144
    s_waitcnt vmcnt(3)
    global_load_lds_dwordx4 v13, s[8:9] nt
    s_xor_b32 m0, s49, 3072
    s_waitcnt vmcnt(3)
    global_load_lds_dwordx4 v14, s[8:9] nt
    s_xor_b32 m0, s49, 7168
    s_waitcnt vmcnt(3)
    global_load_lds_dwordx4 v15, s[8:9] nt
    s_branch L_T2
L_HELP:
    s_lshl_b32 s62, s32, 16
    s_and_b32 s44, s33, 15
    s_getreg_b32 s37, hwreg(HW_REG_XCC_ID, 0, 4)
    s_setprio 3
    s_mov_b32 s34, 8
    s_getpc_b64 s[52:53]
L_PC:
    s_lshl_b32 s46, s33, 9
    v_lshlrev_b32 v3, 7, v0
    v_add_u32 v3, s46, v3
    v_min_u32 v3, L_EXIT-L_PC, v3
    s_mov_b64 exec, 15
    global_load_dword v160, v3, s[52:53]
    s_mov_b64 exec, -1
    s_cmp_lt_u32 s33, 16
    s_cbranch_scc1 L_HT
    s_lshr_b32 s46, s32, 1
    s_and_b32 s50, s32, 0x1
    s_lshl_b32 s50, s50, 4
    s_add_u32 s50, s50, s44
    s_mov_b32 s48, s46
    s_mul_i32 s46, s48, 786432
    s_lshl_b32 s3, s50, 6
    s_add_u32 s46, s46, s3
    v_lshrrev_b32 v20, 2, v0
    v_mul_u32_u24 v20, 6144, v20
    v_and_b32 v3, 3, v0
    v_lshl_add_u32 v20, v3, 4, v20
    v_add_u32 v20, s46, v20
    s_lshl_b32 s46, s48, 8
    v_and_b32 v4, 1, v0
    v_lshlrev_b32 v4, 10, v4
    v_bfe_u32 v3, v0, 1, 2
    v_lshl_add_u32 v4, v3, 6, v4
    v_lshl_add_u32 v4, v2, 4, v4
    v_add_u32 v4, s46, v4
    s_mov_b32 m0, 65536
    s_waitcnt lgkmcnt(0)
    global_load_dwordx4 v[16:19], v4, s[24:25]
    global_load_lds_dwordx4 v20, s[26:27] nt
    v_add_u32 v20, 98304, v20
    s_add_u32 m0, m0, 2048
    s_nop 0
    global_load_lds_dwordx4 v20, s[26:27] nt
    v_add_u32 v20, 98304, v20
    s_add_u32 m0, m0, 2048
    s_nop 0
    global_load_lds_dwordx4 v20, s[26:27] nt
    v_add_u32 v20, 98304, v20
    s_add_u32 m0, m0, 2048
    s_nop 0
    global_load_lds_dwordx4 v20, s[26:27] nt
    v_add_u32 v20, 98304, v20
    s_add_u32 m0, m0, 2048
    s_nop 0
    global_load_lds_dwordx4 v20, s[26:27] nt
    v_add_u32 v20, 98304, v20
    s_add_u32 m0, m0, 2048
    s_nop 0
    global_load_lds_dwordx4 v20, s[26:27] nt
    v_add_u32 v20, 98304, v20
    s_add_u32 m0, m0, 2048
    s_nop 0
    global_load_lds_dwordx4 v20, s[26:27] nt
    v_add_u32 v20, 98304, v20
    s_add_u32 m0, m0, 2048
    s_nop 0
    global_load_lds_dwordx4 v20, s[26:27] nt
    s_load_dword s35, s[30:31], 0
    s_barrier
    s_branch L_H1
L_W:
    s_lshl_b32 s62, s32, 16
    s_and_b32 s44, s33, 15
    s_getreg_b32 s37, hwreg(HW_REG_XCC_ID, 0, 4)
    s_lshl_b32 s46, s32, 10
    s_and_b32 s3, s44, 0x7
    s_lshl_b32 s3, s3, 7
    s_add_u32 s46, s46, s3
    s_and_b32 s3, s44, 0x8
    s_lshl_b32 s3, s3, 18
    s_add_u32 s46, s46, s3
    s_lshl_b32 s3, s34, 18
    s_add_u32 s46, s46, s3
    v_and_b32 v3, 7, v0
    v_and_b32 v4, 1, v2
    v_lshlrev_b32 v4, 1, v4
    v_xor_b32 v3, v3, v4
    v_lshlrev_b32 v3, 4, v3
    v_lshrrev_b32 v4, 3, v0
    v_lshl_add_u32 v3, v4, 13, v3
    v_add_u32 v20, s46, v3
    v_xor_b32 v21, 65600, v20
    v_xor_b32 v22, 131072, v20
    v_xor_b32 v23, 196672, v20
    s_and_b32 s46, s34, 0x4
    s_lshl_b32 s46, s46, 8
    v_lshlrev_b32 v4, 4, v0
    v_add_u32 v4, s46, v4
    s_and_b32 s46, s34, 0x4
    s_lshl_b32 s46, s46, 8
    s_and_b32 s3, s44, 0x8
    s_lshl_b32 s3, s3, 6
    s_add_u32 s46, s46, s3
    s_and_b32 s3, s34, 0x3
    s_lshl_b32 s3, s3, 7
    s_add_u32 s46, s46, s3
    v_lshlrev_b32 v16, 3, v1
    v_bfe_u32 v3, v0, 4, 1
    v_lshl_add_u32 v16, v3, 2, v16
    v_lshrrev_b32 v3, 5, v0
    v_lshl_add_u32 v16, v3, 1, v16
    v_add_u32 v16, s46, v16
    s_lshl_b32 m0, s34, 12
    s_waitcnt lgkmcnt(0)
    s_load_dword s35, s[30:31], 0
    s_barrier
    global_load_dwordx4 v[40:43], v4, s[4:5]
    global_load_short_d16_hi v26, v16, s[4:5]
    global_load_lds_dwordx4 v20, s[10:11] nt
    s_add_u32 m0, m0, 1024
    s_nop 0
    global_load_lds_dwordx4 v21, s[10:11] nt
    s_add_u32 m0, m0, 1024
    s_branch L_W2
L_H1:
    s_mov_b32 s40, 0x07060501
    s_mov_b32 s41, 0x07060502
    s_mov_b32 s42, 0x07060503
    s_mov_b32 s43, 0x0C04000C
    v_bfe_u32 v21, v0, 2, 2
    v_lshlrev_b32 v21, 6, v21
    v_bfe_u32 v3, v0, 4, 1
    v_lshl_add_u32 v21, v3, 9, v21
    v_lshrrev_b32 v3, 5, v0
    v_lshl_add_u32 v21, v3, 11, v21
    v_and_b32 v3, 3, v0
    v_lshl_add_u32 v21, v3, 3, v21
    v_add_u32 v21, 0x10000, v21
    s_mul_i32 s46, s48, 24576
    s_lshl_b32 s3, s50, 8
    s_add_u32 s46, s46, s3
    s_add_u32 s46, s46, 0x30000
    v_lshlrev_b32 v24, 4, v1
    v_add_u32 v24, s46, v24
    v_and_b32 v22, 3, v0
    v_lshlrev_b32 v22, 6, v22
    v_bfe_u32 v3, v0, 2, 1
    v_lshl_add_u32 v22, v3, 5, v22
    v_bfe_u32 v3, v0, 3, 1
    v_lshl_add_u32 v22, v3, 2, v22
    s_mul_i32 s46, s44, 3456
    s_add_u32 s46, s46, s62
    s_add_u32 s46, s46, 0x140000
    v_and_b32 v5, 31, v0
    v_lshlrev_b32 v5, 7, v5
    v_add_u32 v5, s46, v5
    s_mov_b64 exec, 0x7ffffff
    global_load_dword v163, v5, s[30:31]
    s_mov_b64 exec, -1
    s_mul_i32 s46, s48, 786432
    s_lshl_b32 s3, s50, 7
    s_add_u32 s46, s46, s3
    s_add_u32 s46, s46, 0x800
    v_bfe_u32 v20, v0, 2, 3
    v_mul_u32_u24 v20, 6144, v20
    v_and_b32 v3, 3, v0
    v_lshl_add_u32 v20, v3, 4, v20
    v_lshrrev_b32 v3, 5, v0
    v_lshl_add_u32 v20, v3, 6, v20
    v_add_u32 v20, s46, v20
    s_mov_b32 m0, 65536
    s_waitcnt vmcnt(9)
    v_lshlrev_b32 v144, 16, v16
    v_and_b32 v145, 0xffff0000, v16
    v_lshlrev_b32 v146, 16, v17
    v_and_b32 v147, 0xffff0000, v17
    v_lshlrev_b32 v148, 16, v18
    v_and_b32 v149, 0xffff0000, v18
    v_lshlrev_b32 v150, 16, v19
    v_and_b32 v151, 0xffff0000, v19
    v_mul_f32 v152, 0xbfb8aa3b, v144
    v_mul_f32 v153, 0xbfb8aa3b, v145
    v_mul_f32 v154, 0xbfb8aa3b, v146
    v_mul_f32 v155, 0xbfb8aa3b, v147
    v_mul_f32 v156, 0xbfb8aa3b, v148
    v_mul_f32 v157, 0xbfb8aa3b, v149
    v_mul_f32 v158, 0xbfb8aa3b, v150
    v_mul_f32 v159, 0xbfb8aa3b, v151
    v_exp_f32 v152, v152
    v_exp_f32 v153, v153
    v_exp_f32 v154, v154
    v_exp_f32 v155, v155
    v_exp_f32 v156, v156
    v_exp_f32 v157, v157
    v_exp_f32 v158, v158
    v_exp_f32 v159, v159
    v_pk_add_f32 v[152:153], v[152:153], 1.0 op_sel_hi:[1,0]
    v_pk_add_f32 v[154:155], v[154:155], 1.0 op_sel_hi:[1,0]
    v_pk_add_f32 v[156:157], v[156:157], 1.0 op_sel_hi:[1,0]
    v_pk_add_f32 v[158:159], v[158:159], 1.0 op_sel_hi:[1,0]
    v_rcp_f32 v152, v152
    v_rcp_f32 v153, v153
    v_rcp_f32 v154, v154
    v_rcp_f32 v155, v155
    v_rcp_f32 v156, v156
    v_rcp_f32 v157, v157
    v_rcp_f32 v158, v158
    v_rcp_f32 v159, v159
    v_pk_mul_f32 v[152:153], v[144:145], v[152:153]
    v_pk_mul_f32 v[154:155], v[146:147], v[154:155]
    v_pk_mul_f32 v[156:157], v[148:149], v[156:157]
    v_pk_mul_f32 v[158:159], v[150:151], v[158:159]
    v_cvt_pk_bf16_f32 v16, v152, v153
    v_cvt_pk_bf16_f32 v17, v154, v155
    v_cvt_pk_bf16_f32 v18, v156, v157
    v_cvt_pk_bf16_f32 v19, v158, v159
    s_mov_b32 vcc_lo, 0x30003
    s_mov_b32 vcc_hi, 0x30003
    v_cndmask_b32 v112, 0, v16, vcc
    v_cndmask_b32 v113, 0, v17, vcc
    v_cndmask_b32 v114, 0, v18, vcc
    v_cndmask_b32 v115, 0, v19, vcc
    s_mov_b32 vcc_lo, 0xc000c
    s_mov_b32 vcc_hi, 0xc000c
    v_cndmask_b32 v116, 0, v16, vcc
    v_cndmask_b32 v117, 0, v17, vcc
    v_cndmask_b32 v118, 0, v18, vcc
    v_cndmask_b32 v119, 0, v19, vcc
    s_mov_b32 vcc_lo, 0x300030
    s_mov_b32 vcc_hi, 0x300030
    v_cndmask_b32 v120, 0, v16, vcc
    v_cndmask_b32 v121, 0, v17, vcc
    v_cndmask_b32 v122, 0, v18, vcc
    v_cndmask_b32 v123, 0, v19, vcc
    s_mov_b32 vcc_lo, 0xc000c0
    s_mov_b32 vcc_hi, 0xc000c0
    v_cndmask_b32 v124, 0, v16, vcc
    v_cndmask_b32 v125, 0, v17, vcc
    v_cndmask_b32 v126, 0, v18, vcc
    v_cndmask_b32 v127, 0, v19, vcc
    s_mov_b32 vcc_lo, 0x3000300
    s_mov_b32 vcc_hi, 0x3000300
    v_cndmask_b32 v128, 0, v16, vcc
    v_cndmask_b32 v129, 0, v17, vcc
    v_cndmask_b32 v130, 0, v18, vcc
    v_cndmask_b32 v131, 0, v19, vcc
    s_mov_b32 vcc_lo, 0xc000c00
    s_mov_b32 vcc_hi, 0xc000c00
    v_cndmask_b32 v132, 0, v16, vcc
    v_cndmask_b32 v133, 0, v17, vcc
    v_cndmask_b32 v134, 0, v18, vcc
    v_cndmask_b32 v135, 0, v19, vcc
    s_mov_b32 vcc_lo, 0x30003000
    s_mov_b32 vcc_hi, 0x30003000
    v_cndmask_b32 v136, 0, v16, vcc
    v_cndmask_b32 v137, 0, v17, vcc
    v_cndmask_b32 v138, 0, v18, vcc
    v_cndmask_b32 v139, 0, v19, vcc
    s_mov_b32 vcc_lo, 0xc000c000
    s_mov_b32 vcc_hi, 0xc000c000
    v_cndmask_b32 v140, 0, v16, vcc
    v_cndmask_b32 v141, 0, v17, vcc
    v_cndmask_b32 v142, 0, v18, vcc
    v_cndmask_b32 v143, 0, v19, vcc
    s_waitcnt lgkmcnt(0)
    s_mul_i32 s36, s35, 0x9E3779B1
    s_add_u32 s36, s36, 0x7F4A7C15
    s_lshr_b32 s3, s36, 15
    s_xor_b32 s36, s36, s3
    s_mul_i32 s36, s36, 0x85EBCA6B
    v_mov_b32 v39, s36
    s_add_u32 s63, s36, s37
    s_mov_b32 s45, 0
L_AJOB:
    s_waitcnt vmcnt(7)
    ds_read_b64_tr_b16 v[40:41], v21 offset:0
    ds_read_b64_tr_b16 v[42:43], v21 offset:256
    ds_read_b64_tr_b16 v[44:45], v21 offset:32
    ds_read_b64_tr_b16 v[46:47], v21 offset:288
    s_waitcnt vmcnt(5)
    ds_read_b64_tr_b16 v[48:49], v21 offset:4096
    ds_read_b64_tr_b16 v[50:51], v21 offset:4352
    ds_read_b64_tr_b16 v[52:53], v21 offset:4128
    ds_read_b64_tr_b16 v[54:55], v21 offset:4384
    s_waitcnt lgkmcnt(4)
    v_mfma_f32_16x16x32_bf16 v[104:107], v[40:43], v[112:115], 0
    v_mfma_f32_16x16x32_bf16 v[104:107], v[44:47], v[128:131], v[104:107]
    s_waitcnt vmcnt(3)
    ds_read_b64_tr_b16 v[56:57], v21 offset:8192
    ds_read_b64_tr_b16 v[58:59], v21 offset:8448
    ds_read_b64_tr_b16 v[60:61], v21 offset:8224
    ds_read_b64_tr_b16 v[62:63], v21 offset:8480
    s_waitcnt lgkmcnt(4)
    v_mfma_f32_16x16x32_bf16 v[104:107], v[48:51], v[116:119], v[104:107]
    v_mfma_f32_16x16x32_bf16 v[104:107], v[52:55], v[132:135], v[104:107]
    s_waitcnt vmcnt(1)
    ds_read_b64_tr_b16 v[64:65], v21 offset:12288
    ds_read_b64_tr_b16 v[66:67], v21 offset:12544
    ds_read_b64_tr_b16 v[68:69], v21 offset:12320
    ds_read_b64_tr_b16 v[70:71], v21 offset:12576
    s_waitcnt lgkmcnt(4)
    v_mfma_f32_16x16x32_bf16 v[104:107], v[56:59], v[120:123], v[104:107]
    v_mfma_f32_16x16x32_bf16 v[104:107], v[60:63], v[136:139], v[104:107]
    s_waitcnt lgkmcnt(0)
    v_mfma_f32_16x16x32_bf16 v[104:107], v[64:67], v[124:127], v[104:107]
    v_mfma_f32_16x16x32_bf16 v[104:107], v[68:71], v[140:143], v[104:107]
    s_nop 7
    v_add_f32_dpp v104, v104, v104 quad_perm:[2,3,0,1] row_mask:0xf bank_mask:0xf
    v_add_f32_dpp v105, v105, v105 quad_perm:[2,3,0,1] row_mask:0xf bank_mask:0xf
    v_add_f32_dpp v106, v106, v106 quad_perm:[2,3,0,1] row_mask:0xf bank_mask:0xf
    v_add_f32_dpp v107, v107, v107 quad_perm:[2,3,0,1] row_mask:0xf bank_mask:0xf
    v_add_f32_dpp v104, v104, v104 row_shl:4 row_mask:0xf bank_mask:0xf
    v_add_f32_dpp v105, v105, v105 row_shl:4 row_mask:0xf bank_mask:0xf
    v_add_f32_dpp v106, v106, v106 row_shl:4 row_mask:0xf bank_mask:0xf
    v_add_f32_dpp v107, v107, v107 row_shl:4 row_mask:0xf bank_mask:0xf
    v_perm_b32 v32, v104, v107, s40
    v_perm_b32 v33, v105, v107, s41
    v_perm_b32 v34, v106, v107, s42
    ds_bpermute_b32 v36, v22, v32
    ds_bpermute_b32 v37, v22, v33
    ds_bpermute_b32 v38, v22, v34
    s_mov_b64 exec, 0xffff
    s_waitcnt lgkmcnt(0)
    global_store_dwordx4 v24, v[36:39], s[30:31] sc1
    s_mov_b64 exec, -1
    v_add_u32 v21, 512, v21
    v_add_u32 v24, 256, v24
    s_cmp_eq_u32 s45, 0
    s_cbranch_scc1 L_AEND
    s_cmp_eq_u32 s45, 2
    s_cbranch_scc1 L_HW2
    s_mov_b32 s45, 2
    s_branch L_AJOB
L_AEND:
    s_lshl_b32 s46, s33, 2
    s_add_u32 s46, s46, s62
    s_add_u32 s46, s46, 0x14d000
    v_mov_b32 v7, s46
    v_mov_b32 v6, s63
    s_mov_b64 exec, 1
    global_store_dword v7, v6, s[30:31]
    s_mov_b64 exec, -1
    s_barrier
    s_branch L_HW
L_HT:
    v_mov_b32 v28, 132352
    v_mov_b32 v3, 0
    ds_write_b32 v28, v3 offset:4
    v_and_b32 v4, 7, v0
    v_lshlrev_b32 v4, 2, v4
    v_add_u32 v4, 0x20520, v4
    v_mov_b32 v3, 0
    ds_write_b32 v4, v3
    s_waitcnt lgkmcnt(0)
    s_load_dword s35, s[30:31], 0
    s_and_b32 s47, s33, 0x1
    s_lshl_b32 s47, s47, 13
    s_and_b32 s3, s33, 0x2
    s_lshl_b32 s3, s3, 13
    s_add_u32 s47, s47, s3
    s_and_b32 s3, s33, 0x4
    s_lshl_b32 s3, s3, 10
    s_add_u32 s47, s47, s3
    s_and_b32 s3, s33, 0x8
    s_lshl_b32 s3, s3, 8
    s_add_u32 s47, s47, s3
    s_lshl_b32 s3, s32, 8
    s_add_u32 s47, s47, s3
    s_add_u32 s47, s47, 0x8000
    s_xor_b32 s51, s47, 8192
    s_load_dword s52, s[30:31], s47 glc
    s_load_dword s53, s[30:31], s51 glc
    s_mov_b32 s40, 0x07060501
    s_mov_b32 s41, 0x07060502
    s_mov_b32 s42, 0x07060503
    s_mov_b32 s43, 0x0C04000C
    s_waitcnt lgkmcnt(0)
    s_mul_i32 s36, s35, 0x9E3779B1
    s_add_u32 s36, s36, 0x7F4A7C15
    s_lshr_b32 s3, s36, 15
    s_xor_b32 s36, s36, s3
    s_mul_i32 s36, s36, 0x85EBCA6B
    v_mov_b32 v39, s36
    s_add_u32 s63, s36, s37
    s_lshl_b32 s46, s33, 2
    s_add_u32 s46, s46, s62
    s_add_u32 s46, s46, 0x14d000
    v_mov_b32 v7, s46
    v_mov_b32 v6, s63
    s_mov_b64 exec, 1
    global_store_dword v7, v6, s[30:31]
    s_mov_b64 exec, -1
    s_mov_b32 s48, -1
    s_mov_b32 s49, -1
    s_mov_b32 s39, 0
L_PROBE:
    s_memtime s[52:53]
    s_waitcnt lgkmcnt(0)
    s_load_dword s50, s[30:31], s47 glc
    s_waitcnt lgkmcnt(0)
    s_memtime s[54:55]
    s_waitcnt lgkmcnt(0)
    s_sub_u32 s54, s54, s52
    s_min_u32 s48, s48, s54
    s_memtime s[52:53]
    s_waitcnt lgkmcnt(0)
    s_load_dword s50, s[30:31], s51 glc
    s_waitcnt lgkmcnt(0)
    s_memtime s[54:55]
    s_waitcnt lgkmcnt(0)
    s_sub_u32 s54, s54, s52
    s_min_u32 s49, s49, s54
    s_add_u32 s39, s39, 1
    s_cmp_lt_u32 s39, 2
    s_cbranch_scc1 L_PROBE
    s_cmp_lt_u32 s49, s48
    s_cselect_b32 s50, s51, s47
    s_bfe_u32 s50, s50, 0x1000d
    s_add_u32 s50, s50, s36
    s_lshl_b32 s46, s33, 2
    s_add_u32 s46, s46, s62
    s_add_u32 s46, s46, 0x14d080
    v_mov_b32 v6, s50
    v_mov_b32 v7, s46
    s_mov_b64 exec, 1
    global_store_dword v7, v6, s[30:31]
    s_mov_b64 exec, -1
    s_and_b32 s46, s33, 0x8
    s_lshl_b32 s46, s46, 8
    s_add_u32 s46, s46, s62
    s_add_u32 s46, s46, 0x14b800
    v_lshlrev_b32 v19, 4, v0
    v_add_u32 v19, s46, v19
    v_and_b32 v29, 31, v0
    v_lshlrev_b32 v29, 3, v29
    v_lshrrev_b32 v3, 5, v0
    v_mul_u32_u24 v3, 320, v3
    v_add_u32 v29, v29, v3
    v_add_u32 v29, 0x20000, v29
    s_add_u32 s46, s62, 0x14d000
    v_and_b32 v16, 31, v0
    v_lshlrev_b32 v16, 2, v16
    v_add_u32 v16, s46, v16
    s_add_u32 s46, s62, 0x14d080
    v_lshlrev_b32 v17, 2, v1
    v_add_u32 v17, s46, v17
    s_lshl_b32 s46, s32, 19
    s_and_b32 s3, s44, 0x8
    s_lshl_b32 s3, s3, 15
    s_add_u32 s46, s46, s3
    s_and_b32 s3, s44, 0x7
    s_lshl_b32 s3, s3, 7
    s_add_u32 s46, s46, s3
    v_and_b32 v3, 7, v0
    v_and_b32 v4, 1, v2
    v_lshlrev_b32 v4, 1, v4
    v_xor_b32 v3, v3, v4
    v_lshlrev_b32 v3, 4, v3
    v_lshrrev_b32 v4, 3, v0
    v_lshl_add_u32 v3, v4, 10, v3
    v_add_u32 v30, s46, v3
    v_xor_b32 v31, 8256, v30
    s_lshl_b32 s49, s32, 4
    s_add_u32 s49, s49, s44
    s_and_b32 s46, s49, 0x10
    s_lshl_b32 s46, s46, 6
    s_lshr_b32 s3, s49, 5
    s_lshl_b32 s3, s3, 8
    s_add_u32 s46, s46, s3
    s_and_b32 s3, s49, 0x7
    s_lshl_b32 s3, s3, 5
    s_add_u32 s46, s46, s3
    s_and_b32 s3, s49, 0x8
    s_add_u32 s46, s46, s3
    v_and_b32 v60, 1, v0
    v_lshlrev_b32 v60, 4, v60
    v_bfe_u32 v3, v0, 4, 1
    v_lshl_add_u32 v60, v3, 2, v60
    v_lshrrev_b32 v3, 5, v0
    v_lshl_add_u32 v60, v3, 1, v60
    v_add_u32 v60, s46, v60
    v_and_b32 v61, 1023, v60
    s_lshl_b32 s46, s49, 5
    v_and_b32 v4, 1, v0
    v_lshlrev_b32 v4, 4, v4
    v_add_u32 v4, s46, v4
    s_and_b32 s46, s49, 0x10
    s_lshl_b32 s46, s46, 7
    s_lshr_b32 s3, s49, 5
    s_lshl_b32 s3, s3, 9
    s_add_u32 s46, s46, s3
    s_and_b32 s3, s49, 0x7
    s_lshl_b32 s3, s3, 6
    s_add_u32 s46, s46, s3
    s_and_b32 s3, s49, 0x8
    s_lshl_b32 s3, s3, 1
    s_add_u32 s46, s46, s3
    s_add_u32 s46, s46, s62
    s_add_u32 s46, s46, 0x14a000
    v_and_b32 v8, 1, v0
    v_lshlrev_b32 v8, 5, v8
    v_add_u32 v8, s46, v8
    v_bfe_u32 v10, v0, 1, 1
    v_lshlrev_b32 v10, 12, v10
    v_lshrrev_b32 v3, 2, v0
    v_lshl_add_u32 v10, v3, 14, v10
    v_add_u32 v10, 0x50000, v10
    v_bfe_u32 v13, v0, 1, 1
    v_lshlrev_b32 v13, 12, v13
    v_bfe_u32 v3, v0, 2, 3
    v_lshl_add_u32 v13, v3, 14, v13
    v_add_u32 v13, 0x110000, v13
    v_add_u32 v10, v10, v4
    v_add_u32 v13, v13, v4
    s_lshr_b32 s46, s49, 5
    s_lshl_b32 s46, s46, 10
    s_and_b32 s3, s49, 0x6
    s_lshl_b32 s3, s3, 7
    s_add_u32 s46, s46, s3
    s_and_b32 s3, s49, 0x10
    s_lshl_b32 s3, s3, 3
    s_add_u32 s46, s46, s3
    s_and_b32 s3, s49, 0x1
    s_lshl_b32 s3, s3, 6
    s_add_u32 s46, s46, s3
    s_and_b32 s3, s49, 0x8
    s_lshl_b32 s3, s3, 1
    s_add_u32 s46, s46, s3
    s_add_u32 s46, s46, 0x32000
    v_and_b32 v14, 1, v0
    v_lshlrev_b32 v14, 5, v14
    v_bfe_u32 v3, v0, 2, 2
    v_mul_u32_u24 v3, 24576, v3
    v_add_u32 v14, v14, v3
    v_add_u32 v14, s46, v14
    v_add_u32 v15, 12288, v14
    global_load_short_d16_hi v62, v60, s[4:5]
    global_load_short_d16_hi v63, v61, s[22:23]
    global_load_short_d16_hi v161, v60, s[28:29]
    s_lshl_b32 s46, s32, 7
    s_add_u32 s46, s46, 0x1000
    v_mov_b32 v9, s46
    v_mov_b32 v37, 0
    v_mov_b32 v38, 0
    s_mov_b32 s39, 0
    s_mov_b32 m0, 0
prog_1:
    s_sleep 2
    ds_read_b32 v3, v28 offset:4
    s_add_u32 s39, s39, 1
    s_cmp_gt_u32 s39, 100
    s_cbranch_scc1 prog_1_go
    s_waitcnt lgkmcnt(0)
    v_cmp_eq_u32 vcc, 0, v3
    s_cbranch_vccnz prog_1
prog_1_go:
    global_load_dword v5, v16, s[30:31] sc1
    global_load_dword v6, v17, s[30:31] sc1
    global_load_dwordx4 v[20:23], v19, s[30:31] offset:-2048 sc1
    global_load_dwordx4 v[24:27], v19, s[30:31] offset:-1024 sc1
    global_load_dwordx4 v[40:43], v19, s[30:31] offset:2048 sc1
    global_load_dwordx4 v[44:47], v19, s[30:31] offset:3072 sc1
    s_waitcnt vmcnt(4)
    v_cmp_ne_u32 vcc, s63, v5
    s_cmp_eq_u64 vcc, 0
    s_cselect_b32 s38, 1, 0
    s_add_u32 s3, s36, 1
    v_cmp_eq_u32 vcc, s3, v6
    v_cmp_eq_u32 s[52:53], s36, v6
    s_bcnt1_i32_b64 s3, vcc
    s_bcnt1_i32_b64 s50, s[52:53]
    s_cmp_gt_u32 s3, s50
    s_cselect_b32 s50, 8192, 0
    s_or_b32 s46, s50, s38
    v_mov_b32 v5, s46
    ds_write_b32 v28, v5
    s_cmp_lg_u32 s33, 0
    s_cbranch_scc0 L_PGS
    s_waitcnt vmcnt(0)
    s_branch L_NOPG
L_PGS:
    v_mov_b32 v36, s50
    s_mov_b64 exec, 1
    global_store_dwordx4 v9, v[36:39], s[30:31] sc1
    s_mov_b64 exec, -1
L_NOPG:
    s_mov_b32 s39, 0
    s_waitcnt vmcnt(1)
    s_branch poll_2_chk
poll_2:
    s_or_b64 exec, s[52:53], 1
    global_load_dwordx4 v[20:23], v19, s[30:31] offset:-2048 sc1
    s_or_b64 exec, s[54:55], 1
    global_load_dwordx4 v[24:27], v19, s[30:31] offset:-1024 sc1
    s_or_b64 exec, s[56:57], 1
    global_load_dwordx4 v[40:43], v19, s[30:31] offset:2048 sc1
    s_or_b64 exec, s[58:59], 1
    global_load_dwordx4 v[44:47], v19, s[30:31] offset:3072 sc1
    s_mov_b64 exec, -1
    s_add_u32 s39, s39, 1
    s_cmp_gt_u32 s39, 262144
    s_cbranch_scc1 L_END
    s_waitcnt vmcnt(0)
poll_2_chk:
    v_cmp_ne_u32 s[52:53], s36, v23
    v_cmp_ne_u32 s[54:55], s36, v27
    v_cmp_ne_u32 s[56:57], s36, v43
    v_cmp_ne_u32 s[58:59], s36, v47
    s_or_b64 vcc, s[52:53], s[54:55]
    s_or_b64 vcc, vcc, s[56:57]
    s_or_b64 vcc, vcc, s[58:59]
    s_cbranch_scc1 poll_2
    v_perm_b32 v23, v21, v20, s43
    v_perm_b32 v27, v25, v24, s43
    v_perm_b32 v43, v41, v40, s43
    v_perm_b32 v47, v45, v44, s43
    v_lshl_or_b32 v23, v22, 24, v23
    v_lshl_or_b32 v27, v26, 24, v27
    v_lshl_or_b32 v43, v42, 24, v43
    v_lshl_or_b32 v47, v46, 24, v47
    v_pk_add_f32 v[20:21], v[20:21], v[40:41]
    v_pk_add_f32 v[22:23], v[22:23], v[42:43]
    v_pk_add_f32 v[24:25], v[24:25], v[44:45]
    v_pk_add_f32 v[26:27], v[26:27], v[46:47]
    v_cvt_pk_bf16_f32 v20, v20, v21
    v_cvt_pk_bf16_f32 v21, v22, v23
    v_cvt_pk_bf16_f32 v24, v24, v25
    v_cvt_pk_bf16_f32 v25, v26, v27
    ds_write_b64 v29, v[20:21]
    ds_write_b64 v29, v[24:25] offset:640
    s_waitcnt lgkmcnt(0)
    s_barrier
    s_setprio 0
    global_load_lds_dwordx4 v30, s[12:13] nt
    s_add_u32 m0, m0, 1024
    v_add_u32 v30, 16384, v30
    global_load_lds_dwordx4 v31, s[12:13] nt
    s_add_u32 m0, m0, 1024
    v_add_u32 v31, 16384, v31
    global_load_lds_dwordx4 v30, s[12:13] nt
    s_add_u32 m0, m0, 1024
    v_add_u32 v30, 16384, v30
    global_load_lds_dwordx4 v31, s[12:13] nt
    s_add_u32 m0, m0, 1024
    v_add_u32 v31, 16384, v31
    global_load_lds_dwordx4 v30, s[12:13] nt
    s_add_u32 m0, m0, 1024
    v_add_u32 v30, 16384, v30
    global_load_lds_dwordx4 v31, s[12:13] nt
    s_add_u32 m0, m0, 1024
    v_add_u32 v31, 16384, v31
    global_load_lds_dwordx4 v30, s[12:13] nt
    s_add_u32 m0, m0, 1024
    v_add_u32 v30, 16384, v30
    global_load_lds_dwordx4 v31, s[12:13] nt
    s_add_u32 m0, m0, 1024
    v_add_u32 v31, 16384, v31
    global_load_lds_dwordx4 v30, s[12:13] nt
    s_add_u32 m0, m0, 1024
    v_add_u32 v30, 16384, v30
    global_load_lds_dwordx4 v31, s[12:13] nt
    s_add_u32 m0, m0, 1024
    v_add_u32 v31, 16384, v31
    global_load_lds_dwordx4 v30, s[12:13] nt
    s_add_u32 m0, m0, 1024
    v_add_u32 v30, 16384, v30
    global_load_lds_dwordx4 v31, s[12:13] nt
    s_add_u32 m0, m0, 1024
    v_add_u32 v31, 16384, v31
    global_load_lds_dwordx4 v30, s[12:13] nt
    s_add_u32 m0, m0, 1024
    v_add_u32 v30, 16384, v30
    global_load_lds_dwordx4 v31, s[12:13] nt
    s_add_u32 m0, m0, 1024
    v_add_u32 v31, 16384, v31
    global_load_lds_dwordx4 v30, s[12:13] nt
    s_add_u32 m0, m0, 1024
    v_add_u32 v30, 16384, v30
    global_load_lds_dwordx4 v31, s[12:13] nt
    s_add_u32 m0, m0, 1024
    v_add_u32 v31, 16384, v31
    s_barrier
    global_load_lds_dwordx4 v30, s[12:13] nt
    s_add_u32 m0, m0, 1024
    v_add_u32 v30, 16384, v30
    global_load_lds_dwordx4 v31, s[12:13] nt
    s_add_u32 m0, m0, 1024
    v_add_u32 v31, 16384, v31
    global_load_lds_dwordx4 v30, s[12:13] nt
    s_add_u32 m0, m0, 1024
    v_add_u32 v30, 16384, v30
    global_load_lds_dwordx4 v31, s[12:13] nt
    s_add_u32 m0, m0, 1024
    v_add_u32 v31, 16384, v31
    global_load_lds_dwordx4 v30, s[12:13] nt
    s_add_u32 m0, m0, 1024
    v_add_u32 v30, 16384, v30
    global_load_lds_dwordx4 v31, s[12:13] nt
    s_add_u32 m0, m0, 1024
    v_add_u32 v31, 16384, v31
    global_load_lds_dwordx4 v30, s[12:13] nt
    s_add_u32 m0, m0, 1024
    v_add_u32 v30, 16384, v30
    global_load_lds_dwordx4 v31, s[12:13] nt
    s_add_u32 m0, m0, 1024
    v_add_u32 v31, 16384, v31
    global_load_lds_dwordx4 v30, s[12:13] nt
    s_add_u32 m0, m0, 1024
    v_add_u32 v30, 16384, v30
    global_load_lds_dwordx4 v31, s[12:13] nt
    s_add_u32 m0, m0, 1024
    v_add_u32 v31, 16384, v31
    s_barrier
    global_load_lds_dwordx4 v30, s[12:13] nt
    s_add_u32 m0, m0, 1024
    v_add_u32 v30, 16384, v30
    global_load_lds_dwordx4 v31, s[12:13] nt
    s_add_u32 m0, m0, 1024
    v_add_u32 v31, 16384, v31
    global_load_lds_dwordx4 v30, s[12:13] nt
    s_add_u32 m0, m0, 1024
    v_add_u32 v30, 16384, v30
    global_load_lds_dwordx4 v31, s[12:13] nt
    s_add_u32 m0, m0, 1024
    v_add_u32 v31, 16384, v31
    global_load_lds_dwordx4 v30, s[12:13] nt
    s_add_u32 m0, m0, 1024
    v_add_u32 v30, 16384, v30
    global_load_lds_dwordx4 v31, s[12:13] nt
    s_add_u32 m0, m0, 1024
    v_add_u32 v31, 16384, v31
    s_setprio 0
    s_waitcnt vmcnt(0)
    s_barrier
    s_barrier
    s_mov_b32 s39, 0
poll_3:
    global_load_dwordx4 v[40:43], v14, s[30:31] sc1
    global_load_dwordx4 v[44:47], v15, s[30:31] sc1
    global_load_dwordx4 v[48:51], v8, s[30:31] sc1
    global_load_dwordx4 v[52:55], v9, s[30:31] sc1
    s_add_u32 s39, s39, 1
    s_cmp_gt_u32 s39, 262144
    s_cbranch_scc1 L_END
    s_waitcnt vmcnt(0)
    v_cmp_ne_u32 vcc, s36, v43
    v_cmp_ne_u32 s[52:53], s36, v47
    s_or_b64 vcc, vcc, s[52:53]
    v_cmp_ne_u32 s[52:53], s36, v51
    s_or_b64 vcc, vcc, s[52:53]
    v_cmp_ne_u32 s[52:53], s36, v55
    s_or_b64 vcc, vcc, s[52:53]
    s_cbranch_vccnz poll_3
    v_add_u32 v10, v52, v10
    v_add_u32 v13, v52, v13
    v_add_u32 v11, 262144, v10
    v_add_u32 v12, 524288, v10
    s_mov_b32 s54, 0xffff0000
    s_mov_b32 s55, 0xffff0000
    s_mov_b32 s56, 0
    s_mov_b32 s57, -1
    v_perm_b32 v43, v41, v40, s43
    v_perm_b32 v47, v45, v44, s43
    v_perm_b32 v51, v49, v48, s43
    v_lshl_or_b32 v43, v42, 24, v43
    v_lshl_or_b32 v47, v46, 24, v47
    v_lshl_or_b32 v51, v50, 24, v51
    v_add_f32_dpp v40, v40, v40 row_ror:4 row_mask:0xf bank_mask:0xf
    v_add_f32_dpp v41, v41, v41 row_ror:4 row_mask:0xf bank_mask:0xf
    v_add_f32_dpp v42, v42, v42 row_ror:4 row_mask:0xf bank_mask:0xf
    v_add_f32_dpp v43, v43, v43 row_ror:4 row_mask:0xf bank_mask:0xf
    v_add_f32_dpp v44, v44, v44 row_ror:4 row_mask:0xf bank_mask:0xf
    v_add_f32_dpp v45, v45, v45 row_ror:4 row_mask:0xf bank_mask:0xf
    v_add_f32_dpp v46, v46, v46 row_ror:4 row_mask:0xf bank_mask:0xf
    v_add_f32_dpp v47, v47, v47 row_ror:4 row_mask:0xf bank_mask:0xf
    v_add_f32_dpp v40, v40, v40 row_ror:8 row_mask:0xf bank_mask:0xf
    v_add_f32_dpp v41, v41, v41 row_ror:8 row_mask:0xf bank_mask:0xf
    v_add_f32_dpp v42, v42, v42 row_ror:8 row_mask:0xf bank_mask:0xf
    v_add_f32_dpp v43, v43, v43 row_ror:8 row_mask:0xf bank_mask:0xf
    v_add_f32_dpp v44, v44, v44 row_ror:8 row_mask:0xf bank_mask:0xf
    v_add_f32_dpp v45, v45, v45 row_ror:8 row_mask:0xf bank_mask:0xf
    v_add_f32_dpp v46, v46, v46 row_ror:8 row_mask:0xf bank_mask:0xf
    v_add_f32_dpp v47, v47, v47 row_ror:8 row_mask:0xf bank_mask:0xf
    v_cndmask_b32 v40, v40, v42, s[54:55]
    v_cndmask_b32 v41, v41, v43, s[54:55]
    v_cndmask_b32 v30, v40, v41, s[56:57]
    v_cndmask_b32 v44, v44, v46, s[54:55]
    v_cndmask_b32 v45, v45, v47, s[54:55]
    v_cndmask_b32 v31, v44, v45, s[56:57]
    v_cndmask_b32 v48, v48, v50, s[54:55]
    v_cndmask_b32 v49, v49, v51, s[54:55]
    v_cndmask_b32 v32, v48, v49, s[56:57]
    v_cvt_pk_bf16_f32 v31, v30, v31
    v_lshlrev_b32 v30, 16, v31
    v_and_b32 v31, 0xffff0000, v31
    v_and_b32 v62, 0xffff0000, v62
    v_and_b32 v63, 0xffff0000, v63
    v_fmac_f32 v62, v30, v32
    v_cvt_pk_bf16_f32 v62, v62, v62
    v_and_b32 v62, 0xffff0000, v62
    v_fmac_f32 v62, v31, v63
    s_add_u32 s46, s62, 0x14d200
    v_min_u32 v5, 55, v0
    v_lshlrev_b32 v5, 2, v5
    v_add_u32 v5, s46, v5
    s_mov_b32 s39, 0
L_FDW:
    global_load_dword v6, v5, s[30:31] sc1
    s_add_u32 s39, s39, 1
    s_cmp_gt_u32 s39, 16
    s_cbranch_scc1 L_FDW_go
    s_waitcnt vmcnt(0)
    v_cmp_ne_u32 vcc, v6, v39
    s_cbranch_vccnz L_FDW
L_FDW_go:
    s_mov_b32 s39, 0
    s_mov_b64 s[52:53], -1
    s_mov_b64 s[54:55], -1
    s_mov_b64 s[56:57], -1
    s_mov_b64 s[58:59], -1
poll_4:
    s_or_b64 exec, s[52:53], 1
    global_load_dwordx4 v[40:43], v10, s[30:31] sc1
    s_or_b64 exec, s[54:55], 1
    global_load_dwordx4 v[44:47], v11, s[30:31] sc1
    s_or_b64 exec, s[56:57], 1
    global_load_dwordx4 v[48:51], v12, s[30:31] sc1
    s_or_b64 exec, s[58:59], 1
    global_load_dwordx4 v[52:55], v13, s[30:31] sc1
    s_mov_b64 exec, -1
    s_add_u32 s39, s39, 1
    s_cmp_gt_u32 s39, 262144
    s_cbranch_scc1 L_END
    s_waitcnt vmcnt(0)
    v_cmp_ne_u32 s[52:53], s36, v43
    v_cmp_ne_u32 s[54:55], s36, v47
    v_cmp_ne_u32 s[56:57], s36, v51
    v_cmp_ne_u32 s[58:59], s36, v55
    s_or_b64 vcc, s[52:53], s[54:55]
    s_or_b64 vcc, vcc, s[56:57]
    s_or_b64 vcc, vcc, s[58:59]
    s_cbranch_scc1 poll_4
    v_perm_b32 v43, v41, v40, s43
    v_perm_b32 v47, v45, v44, s43
    v_perm_b32 v51, v49, v48, s43
    v_perm_b32 v55, v53, v52, s43
    v_lshl_or_b32 v43, v42, 24, v43
    v_lshl_or_b32 v47, v46, 24, v47
    v_lshl_or_b32 v51, v50, 24, v51
    v_lshl_or_b32 v55, v54, 24, v55
    v_pk_add_f32 v[40:41], v[40:41], v[44:45]
    v_pk_add_f32 v[42:43], v[42:43], v[46:47]
    v_fmac_f32 v48, 0.5, v52
    v_fmac_f32 v49, 0.5, v53
    v_fmac_f32 v50, 0.5, v54
    v_fmac_f32 v51, 0.5, v55
    v_pk_add_f32 v[40:41], v[40:41], v[48:49]
    v_pk_add_f32 v[42:43], v[42:43], v[50:51]
    s_nop 0
    v_permlane32_swap_b32 v40, v41
    v_permlane32_swap_b32 v42, v43
    v_add_f32 v40, v40, v41
    v_add_f32 v42, v42, v43
    s_nop 1
    v_permlane16_swap_b32 v40, v42
    v_add_f32 v40, v40, v42
    s_nop 1
    v_add_f32_dpp v40, v40, v40 quad_perm:[2,3,0,1] row_mask:0xf bank_mask:0xf
    s_nop 1
    v_add_f32_dpp v40, v40, v40 row_ror:4 row_mask:0xf bank_mask:0xf
    s_nop 1
    v_add_f32_dpp v40, v40, v40 row_ror:8 row_mask:0xf bank_mask:0xf
    v_fmac_f32 v62, v31, v40
    v_cvt_pk_bf16_f32 v62, v62, v62
    s_mov_b32 exec_lo, 0x00030003
    s_mov_b32 exec_hi, 0x00030003
    global_store_short v60, v62, s[28:29]
    s_cmp_lg_u32 s49, 0
    s_cbranch_scc1 L_END
    s_add_u32 s35, s35, 1
    v_mov_b32 v3, s35
    v_mov_b32 v4, 0
    s_mov_b64 exec, 1
    global_store_dword v4, v3, s[30:31]
    s_branch L_END
L_HW:
    s_lshl_b32 s46, s50, 8
    s_add_u32 s46, s46, 0x1f00
    v_add_u32 v24, s46, v24
    v_bfe_u32 v21, v0, 2, 2
    v_lshlrev_b32 v21, 6, v21
    v_lshl_add_u32 v21, v2, 10, v21
    v_and_b32 v3, 3, v0
    v_lshl_add_u32 v21, v3, 3, v21
    v_add_u32 v21, 0x10000, v21
    s_add_u32 s46, s62, 0x14d080
    v_lshlrev_b32 v9, 2, v1
    v_add_u32 v9, s46, v9
    s_lshr_b32 s46, s44, 1
    s_lshl_b32 s46, s46, 14
    s_and_b32 s3, s44, 0x1
    s_lshl_b32 s3, s3, 12
    s_add_u32 s46, s46, s3
    s_add_u32 s46, s46, 0x10000
    v_and_b32 v10, 31, v0
    v_lshlrev_b32 v10, 7, v10
    v_add_u32 v10, s46, v10
    s_mul_i32 s46, s44, 7
    v_lshrrev_b32 v3, 2, v0
    v_min_u32 v3, 6, v3
    v_add_u32 v3, s46, v3
    v_lshrrev_b32 v4, 1, v3
    v_and_b32 v3, 1, v3
    v_lshlrev_b32 v4, 14, v4
    v_lshl_add_u32 v4, v3, 12, v4
    s_lshl_b32 s46, s32, 9
    s_add_u32 s46, s46, 0x50000
    v_and_b32 v11, 3, v0
    v_lshlrev_b32 v11, 7, v11
    v_add_u32 v11, s46, v11
    v_add_u32 v11, v11, v4
    s_add_u32 s46, s62, 0x14d100
    v_lshlrev_b32 v5, 2, v1
    v_add_u32 v5, s46, v5
    s_barrier
    s_barrier
    global_load_dword v8, v9, s[30:31] sc1
    global_load_lds_dwordx4 v20, s[26:27] nt
    s_add_u32 m0, m0, 1024
    v_add_u32 v20, 49152, v20
    global_load_lds_dwordx4 v20, s[26:27] nt
    s_add_u32 m0, m0, 1024
    v_add_u32 v20, 49152, v20
    global_load_lds_dwordx4 v20, s[26:27] nt
    s_add_u32 m0, m0, 1024
    v_add_u32 v20, 49152, v20
    global_load_lds_dwordx4 v20, s[26:27] nt
    s_add_u32 m0, m0, 1024
    v_add_u32 v20, 49152, v20
    global_load_lds_dwordx4 v20, s[26:27] nt
    s_add_u32 m0, m0, 1024
    v_add_u32 v20, 49152, v20
    global_load_lds_dwordx4 v20, s[26:27] nt
    s_add_u32 m0, m0, 1024
    v_add_u32 v20, 49152, v20
    global_load_lds_dwordx4 v20, s[26:27] nt
    s_add_u32 m0, m0, 1024
    v_add_u32 v20, 49152, v20
    global_load_lds_dwordx4 v20, s[26:27] nt
    s_add_u32 m0, m0, 1024
    v_add_u32 v20, 49152, v20
    global_load_lds_dwordx4 v20, s[26:27] nt
    s_add_u32 m0, m0, 1024
    v_add_u32 v20, 49152, v20
    global_load_lds_dwordx4 v20, s[26:27] nt
    s_add_u32 m0, m0, 1024
    v_add_u32 v20, 49152, v20
    global_load_lds_dwordx4 v20, s[26:27] nt
    s_add_u32 m0, m0, 1024
    v_add_u32 v20, 49152, v20
    global_load_lds_dwordx4 v20, s[26:27] nt
    s_add_u32 m0, m0, 1024
    v_add_u32 v20, 49152, v20
    global_load_lds_dwordx4 v20, s[26:27] nt
    s_add_u32 m0, m0, 1024
    v_add_u32 v20, 49152, v20
    global_load_lds_dwordx4 v20, s[26:27] nt
    s_add_u32 m0, m0, 1024
    v_add_u32 v20, 49152, v20
    global_load_lds_dwordx4 v20, s[26:27] nt
    s_add_u32 m0, m0, 1024
    v_add_u32 v20, 49152, v20
    global_load_lds_dwordx4 v20, s[26:27] nt
    s_add_u32 m0, m0, 1024
    v_add_u32 v20, 49152, v20
    s_barrier
    s_waitcnt vmcnt(0)
    s_barrier
    s_mov_b32 s45, 1
    s_waitcnt vmcnt(0)
    s_branch L_AJOB
L_HW2:
    s_add_u32 s3, s36, 1
    v_cmp_eq_u32 vcc, s3, v8
    v_cmp_eq_u32 s[52:53], s36, v8
    s_bcnt1_i32_b64 s3, vcc
    s_bcnt1_i32_b64 s46, s[52:53]
    s_cmp_gt_u32 s3, s46
    s_cselect_b32 s46, 8192, 0
    v_add_u32 v10, s46, v10
    v_add_u32 v11, s46, v11
    s_mov_b32 exec_hi, 0
    global_load_dword v162, v10, s[30:31]
    global_load_dword v163, v11, s[30:31]
    s_mov_b64 exec, -1
    s_barrier
    s_branch L_END
L_T2:
    s_mov_b32 s40, 0x07060501
    s_mov_b32 s41, 0x07060502
    s_mov_b32 s42, 0x07060503
    s_mov_b32 s43, 0x0C04000C
    v_and_b32 v3, 7, v1
    v_lshlrev_b32 v3, 1, v3
    v_xor_b32 v3, v3, v2
    v_lshlrev_b32 v3, 4, v3
    v_lshl_or_b32 v3, v1, 8, v3
    s_lshl_b32 s46, s34, 13
    v_add_u32 v24, s46, v3
    v_xor_b32 v25, 64, v24
    v_xor_b32 v26, 128, v24
    v_xor_b32 v27, 192, v24
    ds_read_b128 v[40:43], v24 offset:0
    ds_read_b128 v[44:47], v25 offset:0
    ds_read_b128 v[48:51], v26 offset:0
    ds_read_b128 v[52:55], v27 offset:0
    ds_read_b128 v[56:59], v24 offset:4096
    ds_read_b128 v[60:63], v25 offset:4096
    ds_read_b128 v[64:67], v26 offset:4096
    ds_read_b128 v[68:71], v27 offset:4096
    v_lshrrev_b32 v3, 2, v1
    v_lshl_add_u32 v4, v2, 2, v3
    v_and_b32 v5, 7, v4
    v_lshlrev_b32 v5, 1, v5
    v_bfe_u32 v6, v1, 1, 1
    s_lshl_b32 s46, s34, 1
    v_add_u32 v6, s46, v6
    v_xor_b32 v5, v5, v6
    v_lshlrev_b32 v5, 4, v5
    v_lshl_or_b32 v5, v4, 8, v5
    v_and_b32 v6, 1, v1
    v_lshl_or_b32 v5, v6, 3, v5
    v_add_u32 v28, 65536, v5
    v_and_b32 v30, 3, v0
    v_mul_u32_u24 v30, 320, v30
    v_lshl_add_u32 v30, v2, 4, v30
    v_add_u32 v30, 0x20000, v30
    v_and_b32 v31, 3, v0
    v_lshlrev_b32 v31, 6, v31
    v_lshl_add_u32 v31, v2, 4, v31
    v_bfe_u32 v3, v0, 2, 2
    v_mul_u32_u24 v3, 288, v3
    v_add_u32 v31, v31, v3
    v_add_u32 v31, 0x20600, v31
    s_mul_i32 s46, s34, 288
    s_add_u32 s46, s46, 0x20600
    v_and_b32 v32, 3, v0
    v_lshlrev_b32 v32, 6, v32
    v_lshl_add_u32 v32, v2, 4, v32
    v_bfe_u32 v3, v0, 2, 2
    v_lshl_add_u32 v32, v3, 2, v32
    v_add_u32 v32, s46, v32
    v_and_b32 v33, 3, v0
    v_mul_u32_u24 v33, 144, v33
    v_bfe_u32 v3, v0, 2, 2
    v_lshl_add_u32 v33, v3, 5, v33
    v_add_u32 v33, 0x21600, v33
    s_lshl_b32 s46, s34, 4
    s_add_u32 s46, s46, 0x21600
    v_and_b32 v34, 3, v0
    v_mul_u32_u24 v34, 144, v34
    v_lshl_add_u32 v34, v2, 2, v34
    v_add_u32 v34, s46, v34
    v_mov_b32 v140, 0x3f803f80
    v_mov_b32 v141, 0x3f803f80
    v_mov_b32 v142, 0x3f803f80
    v_mov_b32 v143, 0x3f803f80
    s_lshl_b32 s46, s34, 10
    s_lshl_b32 s3, s33, 4
    s_add_u32 s46, s46, s3
    s_add_u32 s46, s46, s62
    s_add_u32 s46, s46, 0x140000
    v_and_b32 v35, 3, v0
    v_lshlrev_b32 v35, 13, v35
    v_lshl_add_u32 v35, v2, 8, v35
    v_add_u32 v35, s46, v35
    s_lshl_b32 s47, s44, 8
    s_and_b32 s3, s34, 0x2
    s_lshl_b32 s3, s3, 6
    s_add_u32 s47, s47, s3
    v_and_b32 v4, 7, v0
    v_lshlrev_b32 v4, 4, v4
    v_add_u32 v4, s47, v4
    s_add_u32 s46, s62, 0x14a000
    v_add_u32 v7, s46, v4
    v_lshrrev_b32 v9, 3, v0
    v_lshlrev_b32 v9, 14, v9
    v_add_u32 v9, 0x10800, v9
    v_add_u32 v9, v9, v4
    s_lshl_b32 s46, s32, 14
    s_and_b32 s3, s44, 0x8
    s_lshl_b32 s3, s3, 9
    s_add_u32 s46, s46, s3
    s_and_b32 s3, s44, 0x7
    s_lshl_b32 s3, s3, 8
    s_add_u32 s46, s46, s3
    s_add_u32 s46, s46, 0x10000
    v_lshlrev_b32 v17, 4, v1
    v_bfe_u32 v3, v0, 4, 1
    v_lshl_add_u32 v17, v3, 11, v17
    v_lshrrev_b32 v3, 5, v0
    v_lshl_add_u32 v17, v3, 13, v17
    v_add_u32 v17, s46, v17
    s_lshl_b32 s46, s34, 9
    s_add_u32 s46, s46, 0x9000
    v_lshrrev_b32 v10, 5, v0
    v_lshlrev_b32 v10, 8, v10
    v_bfe_u32 v3, v0, 4, 1
    v_lshl_add_u32 v10, v3, 6, v10
    v_lshl_add_u32 v10, v1, 2, v10
    v_add_u32 v10, s46, v10
    v_lshlrev_b32 v6, 4, v2
    v_and_b32 v11, 31, v0
    v_lshlrev_b32 v11, 4, v11
    v_lshrrev_b32 v3, 5, v0
    v_lshl_add_u32 v11, v3, 11, v11
    v_add_u32 v11, 0x9000, v11
    s_lshl_b32 s46, s34, 2
    s_add_u32 s46, s46, 0x20520
    v_mov_b32 v12, s46
    v_and_b32 v13, 7, v0
    v_lshlrev_b32 v13, 2, v13
    v_add_u32 v13, 0x20520, v13
    s_and_b32 s46, s44, 0x8
    s_lshl_b32 s46, s46, 11
    s_lshl_b32 s3, s34, 11
    s_add_u32 s46, s46, s3
    s_add_u32 s46, s46, s62
    s_add_u32 s46, s46, 0x140000
    v_lshlrev_b32 v8, 4, v1
    v_lshl_add_u32 v8, v2, 9, v8
    v_add_u32 v8, s46, v8
    s_lshl_b32 s46, s34, 12
    v_bfe_u32 v18, v0, 2, 2
    v_lshlrev_b32 v18, 7, v18
    v_lshl_add_u32 v18, v2, 10, v18
    v_bfe_u32 v3, v0, 3, 1
    v_lshl_add_u32 v18, v3, 5, v18
    v_bfe_u32 v3, v0, 4, 1
    v_lshl_add_u32 v18, v3, 6, v18
    v_bfe_u32 v3, v0, 1, 1
    v_lshl_add_u32 v18, v3, 4, v18
    v_and_b32 v3, 1, v0
    v_lshl_add_u32 v18, v3, 3, v18
    v_add_u32 v18, s46, v18
    v_xor_b32 v19, 32, v18
    v_xor_b32 v20, 64, v18
    v_xor_b32 v21, 96, v18
    s_and_b32 s46, s44, 0x7
    s_lshl_b32 s46, s46, 9
    s_and_b32 s3, s44, 0x8
    s_lshl_b32 s3, s3, 4
    s_add_u32 s46, s46, s3
    s_add_u32 s46, s46, 0x33000
    v_and_b32 v14, 7, v0
    v_lshlrev_b32 v14, 4, v14
    v_bfe_u32 v3, v0, 3, 1
    v_lshl_add_u32 v14, v3, 8, v14
    v_mul_u32_u24 v3, 24576, v2
    v_add_u32 v14, v14, v3
    v_add_u32 v14, s46, v14
    v_add_u32 v15, 4096, v14
    s_lshl_b32 s46, s44, 8
    s_add_u32 s46, s46, s62
    s_add_u32 s46, s46, 0x148000
    v_lshlrev_b32 v22, 4, v1
    v_bfe_u32 v3, v0, 4, 1
    v_lshl_add_u32 v22, v3, 12, v22
    v_add_u32 v22, s46, v22
    s_mov_b32 s54, 0xf0f0f0f0
    s_mov_b32 s55, 0xf0f0f0f0
    s_mov_b32 s56, 0xff00ff00
    s_mov_b32 s57, 0xff00ff00
    s_waitcnt lgkmcnt(0)
    s_mul_i32 s36, s35, 0x9E3779B1
    s_add_u32 s36, s36, 0x7F4A7C15
    s_lshr_b32 s3, s36, 15
    s_xor_b32 s36, s36, s3
    s_mul_i32 s36, s36, 0x85EBCA6B
    v_mov_b32 v39, s36
    s_add_u32 s63, s36, s37
    s_waitcnt vmcnt(0)
    s_waitcnt lgkmcnt(0)
    s_barrier
    ds_read_b128 v[104:107], v30 offset:0
    ds_read_b128 v[108:111], v30 offset:64
    ds_read_b128 v[112:115], v30 offset:128
    ds_read_b128 v[116:119], v30 offset:192
    s_waitcnt lgkmcnt(3)
    v_mfma_f32_16x16x32_bf16 v[120:123], v[40:43], v[104:107], 0
    v_mfma_f32_16x16x32_bf16 v[124:127], v[56:59], v[104:107], 0
    ds_read_b64_tr_b16 v[76:77], v28 offset:8192
    ds_read_b64_tr_b16 v[78:79], v28 offset:12288
    s_waitcnt lgkmcnt(4)
    v_mfma_f32_16x16x32_bf16 v[120:123], v[44:47], v[108:111], v[120:123]
    v_mfma_f32_16x16x32_bf16 v[124:127], v[60:63], v[108:111], v[124:127]
    ds_read_b64_tr_b16 v[92:93], v28 offset:40960
    ds_read_b64_tr_b16 v[94:95], v28 offset:45056
    s_waitcnt lgkmcnt(5)
    v_mfma_f32_16x16x32_bf16 v[120:123], v[48:51], v[112:115], v[120:123]
    v_mfma_f32_16x16x32_bf16 v[124:127], v[64:67], v[112:115], v[124:127]
    ds_read_b64_tr_b16 v[72:73], v28 offset:0
    ds_read_b64_tr_b16 v[74:75], v28 offset:4096
    s_waitcnt lgkmcnt(6)
    v_mfma_f32_16x16x32_bf16 v[120:123], v[52:55], v[116:119], v[120:123]
    v_mfma_f32_16x16x32_bf16 v[124:127], v[68:71], v[116:119], v[124:127]
    ds_read_b64_tr_b16 v[88:89], v28 offset:32768
    ds_read_b64_tr_b16 v[90:91], v28 offset:36864
    s_nop 5
    v_cndmask_b32 v120, v120, v124, s[56:57]
    v_cndmask_b32 v121, v121, v125, s[56:57]
    v_cndmask_b32 v122, v122, v126, s[56:57]
    v_cndmask_b32 v123, v123, v127, s[56:57]
    v_cndmask_b32 v120, v120, v122, s[54:55]
    v_cndmask_b32 v121, v121, v123, s[54:55]
    v_cvt_pk_bf16_f32 v121, v120, v121
    v_lshlrev_b32 v120, 16, v121
    v_and_b32 v121, 0xffff0000, v121
    v_mul_f32 v120, 0x3db504f3, v120
    v_mul_f32 v121, 0x3db504f3, v121
    v_cvt_pk_bf16_f32 v121, v120, v121
    v_lshlrev_b32 v120, 16, v121
    v_and_b32 v121, 0xffff0000, v121
    v_mul_f32 v120, 0x3fb8aa3b, v120
    v_mul_f32 v121, 0x3fb8aa3b, v121
    v_max_f32 v122, v120, v121
    s_nop 1
    v_max_f32_dpp v122, v122, v122 row_ror:4 row_mask:0xf bank_mask:0xf
    s_nop 1
    v_max_f32_dpp v122, v122, v122 row_ror:8 row_mask:0xf bank_mask:0xf
    s_mov_b32 exec_lo, 0x000f000f
    s_mov_b32 exec_hi, 0x000f000f
    ds_write_b32 v34, v122
    s_mov_b64 exec, -1
    s_waitcnt lgkmcnt(0)
    s_barrier
    ds_read_b128 v[104:107], v33
    ds_read_b128 v[108:111], v33 offset:16
    ds_read_b32 v16, v29
    s_waitcnt lgkmcnt(1)
    v_max3_f32 v104, v104, v105, v106
    v_max3_f32 v107, v107, v108, v109
    v_max3_f32 v104, v104, v110, v111
    v_max_f32 v122, v104, v107
    s_nop 1
    v_max_f32_dpp v122, v122, v122 row_ror:4 row_mask:0xf bank_mask:0xf
    s_nop 1
    v_max_f32_dpp v122, v122, v122 row_ror:8 row_mask:0xf bank_mask:0xf
    v_sub_f32 v120, v120, v122
    v_sub_f32 v121, v121, v122
    v_exp_f32 v120, v120
    v_exp_f32 v121, v121
    s_nop 0
    v_cvt_pk_bf16_f32 v124, v120, v121
    ds_write_b32 v32, v124
    s_waitcnt lgkmcnt(0)
    s_barrier
    ds_read_b128 v[40:43], v31
    ds_read_b128 v[44:47], v31 offset:1152
    v_readfirstlane_b32 s38, v16
    v_and_b32 v16, 8192, v16
    v_add_u32 v9, v9, v16
    s_and_b32 s38, s38, 1
    ds_read_b64_tr_b16 v[80:81], v28 offset:16384
    ds_read_b64_tr_b16 v[82:83], v28 offset:20480
    ds_read_b64_tr_b16 v[96:97], v28 offset:49152
    ds_read_b64_tr_b16 v[98:99], v28 offset:53248
    ds_read_b64_tr_b16 v[84:85], v28 offset:24576
    ds_read_b64_tr_b16 v[86:87], v28 offset:28672
    ds_read_b64_tr_b16 v[100:101], v28 offset:57344
    ds_read_b64_tr_b16 v[102:103], v28 offset:61440
    s_waitcnt lgkmcnt(9)
    v_mfma_f32_16x16x32_bf16 v[104:107], v[140:143], v[40:43], 0
    v_mfma_f32_16x16x32_bf16 v[52:55], v[76:79], v[40:43], 0
    s_waitcnt lgkmcnt(8)
    v_mfma_f32_16x16x32_bf16 v[104:107], v[140:143], v[44:47], v[104:107]
    v_mfma_f32_16x16x32_bf16 v[52:55], v[92:95], v[44:47], v[52:55]
    v_mfma_f32_16x16x32_bf16 v[48:51], v[72:75], v[40:43], 0
    v_mfma_f32_16x16x32_bf16 v[48:51], v[88:91], v[44:47], v[48:51]
    s_waitcnt lgkmcnt(6)
    v_mfma_f32_16x16x32_bf16 v[56:59], v[80:83], v[40:43], 0
    s_waitcnt lgkmcnt(4)
    v_mfma_f32_16x16x32_bf16 v[56:59], v[96:99], v[44:47], v[56:59]
    s_waitcnt lgkmcnt(2)
    v_mfma_f32_16x16x32_bf16 v[60:63], v[84:87], v[40:43], 0
    s_waitcnt lgkmcnt(0)
    v_mfma_f32_16x16x32_bf16 v[60:63], v[100:103], v[44:47], v[60:63]
    v_add_f32_dpp v104, v104, v104 row_ror:4 row_mask:0xf bank_mask:0xf
    v_add_f32_dpp v48, v52, v48 row_shl:4 row_mask:0xf bank_mask:0xf
    v_add_f32_dpp v49, v53, v49 row_shl:4 row_mask:0xf bank_mask:0xf
    v_add_f32_dpp v104, v104, v104 row_ror:8 row_mask:0xf bank_mask:0xf
    v_add_f32_dpp v50, v54, v50 row_shl:4 row_mask:0xf bank_mask:0xf
    v_add_f32_dpp v51, v55, v51 row_shl:4 row_mask:0xf bank_mask:0xf
    v_rcp_f32 v105, v104
    v_log_f32 v38, v104
    v_add_f32_dpp v48, v56, v48 row_shl:8 row_mask:0xf bank_mask:0xf
    v_add_f32_dpp v49, v57, v49 row_shl:8 row_mask:0xf bank_mask:0xf
    v_add_f32_dpp v50, v58, v50 row_shl:8 row_mask:0xf bank_mask:0xf
    v_add_f32_dpp v51, v59, v51 row_shl:8 row_mask:0xf bank_mask:0xf
    v_add_f32_dpp v48, v60, v48 row_shl:12 row_mask:0xf bank_mask:0xf
    v_add_f32_dpp v49, v61, v49 row_shl:12 row_mask:0xf bank_mask:0xf
    v_add_f32_dpp v50, v62, v50 row_shl:12 row_mask:0xf bank_mask:0xf
    v_add_f32_dpp v51, v63, v51 row_shl:12 row_mask:0xf bank_mask:0xf
    v_add_f32 v38, v38, v122
    v_pk_mul_f32 v[48:49], v[48:49], v[104:105] op_sel:[0,1] op_sel_hi:[1,1]
    v_pk_mul_f32 v[50:51], v[50:51], v[104:105] op_sel:[0,1] op_sel_hi:[1,1]
    v_cvt_pk_bf16_f32 v36, v48, v49
    v_cvt_pk_bf16_f32 v37, v50, v51
    s_mov_b32 exec_lo, 0x000f000f
    s_mov_b32 exec_hi, 0x000f000f
    s_cmp_eq_u32 s38, 0
    s_cbranch_scc1 stg_5
    global_store_dwordx4 v35, v[36:39], s[30:31]
    s_branch std_6
stg_5:
    global_store_dwordx4 v35, v[36:39], s[30:31] sc1
std_6:
    s_mov_b64 exec, -1
    s_barrier
    global_load_dwordx4 v[40:43], v8, s[30:31] sc1
    global_load_dwordx4 v[44:47], v8, s[30:31] offset:256 sc1
    ds_read_b64_tr_b16 v[100:101], v18 offset:0
    ds_read_b64_tr_b16 v[102:103], v18 offset:512
    ds_read_b64_tr_b16 v[104:105], v19 offset:0
    ds_read_b64_tr_b16 v[106:107], v19 offset:512
    ds_read_b64_tr_b16 v[108:109], v20 offset:0
    ds_read_b64_tr_b16 v[110:111], v20 offset:512
    ds_read_b64_tr_b16 v[112:113], v21 offset:0
    ds_read_b64_tr_b16 v[114:115], v21 offset:512
    s_mov_b32 s39, 0
    s_waitcnt vmcnt(0)
    s_branch poll_7_chk
poll_7:
    s_or_b64 exec, s[52:53], 1
    global_load_dwordx4 v[40:43], v8, s[30:31] sc1
    s_or_b64 exec, s[54:55], 1
    global_load_dwordx4 v[44:47], v8, s[30:31] offset:256 sc1
    s_mov_b64 exec, -1
    s_add_u32 s39, s39, 1
    s_cmp_gt_u32 s39, 262144
    s_cbranch_scc1 L_END
    s_waitcnt vmcnt(0)
poll_7_chk:
    v_cmp_ne_u32 s[52:53], s36, v43
    v_cmp_ne_u32 s[54:55], s36, v47
    s_or_b64 vcc, s[52:53], s[54:55]
    s_cbranch_scc1 poll_7
    s_cmp_lg_u32 s34, 3
    s_cbranch_scc1 L_NORP
    global_load_dwordx4 v[128:131], v14, s[30:31] sc1
    global_load_dwordx4 v[132:135], v15, s[30:31] sc1
    global_load_dwordx4 v[136:139], v14, s[30:31] offset:-4096 sc1
L_NORP:
    v_max_f32_dpp v56, v46, v46 quad_perm:[1,0,3,2] row_mask:0xf bank_mask:0xf
    v_mov_b32 v42, v44
    v_mov_b32 v43, v45
    v_max_f32_dpp v56, v56, v56 quad_perm:[2,3,0,1] row_mask:0xf bank_mask:0xf
    s_waitcnt lgkmcnt(0)
    v_mfma_f32_16x16x32_bf16 v[80:83], v[40:43], v[100:103], 0
    v_max_f32_dpp v56, v56, v56 row_half_mirror row_mask:0xf bank_mask:0xf
    v_sub_f32 v56, v46, v56
    v_exp_f32 v56, v56
    v_mfma_f32_16x16x32_bf16 v[84:87], v[40:43], v[104:107], 0
    ds_bpermute_b32 v48, v6, v56 offset:0
    ds_bpermute_b32 v49, v6, v56 offset:4
    ds_bpermute_b32 v50, v6, v56 offset:8
    ds_bpermute_b32 v51, v6, v56 offset:12
    v_mfma_f32_16x16x32_bf16 v[88:91], v[40:43], v[108:111], 0
    v_mfma_f32_16x16x32_bf16 v[92:95], v[40:43], v[112:115], 0
    s_waitcnt lgkmcnt(0)
    v_pk_add_f32 v[52:53], v[48:49], v[50:51]
    v_pk_mul_f32 v[80:81], v[80:81], v[48:49]
    v_pk_mul_f32 v[84:85], v[84:85], v[48:49]
    s_nop 2
    v_pk_mul_f32 v[88:89], v[88:89], v[48:49]
    v_pk_mul_f32 v[92:93], v[92:93], v[48:49]
    v_add_f32 v52, v52, v53
    v_pk_fma_f32 v[80:81], v[82:83], v[50:51], v[80:81]
    v_pk_fma_f32 v[84:85], v[86:87], v[50:51], v[84:85]
    v_pk_fma_f32 v[88:89], v[90:91], v[50:51], v[88:89]
    v_pk_fma_f32 v[92:93], v[94:95], v[50:51], v[92:93]
    v_mov_b32 v53, v52
    v_add_f32 v80, v80, v81
    v_add_f32 v84, v84, v85
    v_add_f32 v88, v88, v89
    v_add_f32 v92, v92, v93
    v_permlane16_swap_b32 v52, v53
    v_permlane16_swap_b32 v80, v84
    v_permlane16_swap_b32 v88, v92
    v_add_f32 v52, v52, v53
    v_rcp_f32 v52, v52
    v_add_f32 v80, v80, v84
    v_add_f32 v88, v88, v92
    v_mul_f32 v80, v80, v52
    v_mul_f32 v88, v88, v52
    ds_write2_b32 v10, v80, v88 offset1:32
    s_mov_b64 exec, 1
    ds_write_b32 v12, v12
    s_mov_b64 exec, -1
    s_cmp_ge_u32 s34, 3
    s_cbranch_scc1 L_RELAY
    s_mov_b32 s39, 0
L_RW:
    ds_read_b32 v3, v13
    ds_read_b128 v[40:43], v11 offset:0
    ds_read_b128 v[44:47], v11 offset:512
    ds_read_b128 v[48:51], v11 offset:1024
    ds_read_b128 v[52:55], v11 offset:1536
    s_add_u32 s39, s39, 1
    s_cmp_gt_u32 s39, 262144
    s_cbranch_scc1 L_END
    s_waitcnt lgkmcnt(0)
    v_cmp_eq_u32 vcc, 0, v3
    s_cbranch_vccnz L_RW
    s_cmp_lg_u32 s34, 0
    s_cbranch_scc1 L_R2
    v_pk_add_f32 v[40:41], v[40:41], v[44:45]
    v_pk_add_f32 v[42:43], v[42:43], v[46:47]
    v_pk_add_f32 v[48:49], v[48:49], v[52:53]
    v_pk_add_f32 v[50:51], v[50:51], v[54:55]
    v_pk_add_f32 v[40:41], v[40:41], v[48:49]
    v_pk_add_f32 v[42:43], v[42:43], v[50:51]
    v_pk_mov_b32 v[44:45], v[40:41], v[40:41] op_sel:[0,1]
    v_pk_mov_b32 v[46:47], v[42:43], v[42:43] op_sel:[0,1]
    s_nop 0
    v_permlane32_swap_b32 v40, v44
    v_permlane32_swap_b32 v41, v45
    v_permlane32_swap_b32 v42, v46
    v_permlane32_swap_b32 v43, v47
    v_pk_add_f32 v[40:41], v[40:41], v[44:45]
    v_pk_add_f32 v[42:43], v[42:43], v[46:47]
    v_perm_b32 v36, v40, v43, s40
    v_perm_b32 v37, v41, v43, s41
    v_perm_b32 v38, v42, v43, s42
    global_store_dwordx4 v17, v[36:39], s[30:31] sc1
    s_branch L_END
L_R2:
    s_mov_b32 s39, 0
    s_mov_b64 s[52:53], -1
    s_mov_b64 s[54:55], -1
    global_load_dwordx4 v[40:43], v9, s[30:31] offset:-2048 sc1
    global_load_dwordx4 v[44:47], v9, s[30:31] offset:2048 sc1
    s_sleep 2
poll_8:
    s_or_b64 exec, s[52:53], 1
    global_load_dwordx4 v[40:43], v9, s[30:31] offset:-2048 sc1
    s_or_b64 exec, s[54:55], 1
    global_load_dwordx4 v[44:47], v9, s[30:31] offset:2048 sc1
    s_mov_b64 exec, -1
    s_add_u32 s39, s39, 1
    s_cmp_gt_u32 s39, 262144
    s_cbranch_scc1 L_END
    s_waitcnt vmcnt(2)
    v_cmp_ne_u32 s[52:53], s36, v43
    v_cmp_ne_u32 s[54:55], s36, v47
    s_or_b64 vcc, s[52:53], s[54:55]
    s_cbranch_scc1 poll_8
    s_waitcnt vmcnt(0)
    v_perm_b32 v43, v41, v40, s43
    v_perm_b32 v47, v45, v44, s43
    v_lshl_or_b32 v43, v42, 24, v43
    v_lshl_or_b32 v47, v46, 24, v47
    v_pk_add_f32 v[40:41], v[40:41], v[44:45]
    v_pk_add_f32 v[42:43], v[42:43], v[46:47]
    s_nop 0
    v_add_f32_dpp v40, v40, v40 row_ror:8 row_mask:0xf bank_mask:0xf
    v_add_f32_dpp v41, v41, v41 row_ror:8 row_mask:0xf bank_mask:0xf
    v_add_f32_dpp v42, v42, v42 row_ror:8 row_mask:0xf bank_mask:0xf
    v_add_f32_dpp v43, v43, v43 row_ror:8 row_mask:0xf bank_mask:0xf
    v_pk_mov_b32 v[44:45], v[40:41], v[40:41] op_sel:[0,1]
    v_pk_mov_b32 v[46:47], v[42:43], v[42:43] op_sel:[0,1]
    s_nop 0
    v_permlane16_swap_b32 v40, v44
    v_permlane16_swap_b32 v41, v45
    v_permlane16_swap_b32 v42, v46
    v_permlane16_swap_b32 v43, v47
    v_pk_add_f32 v[40:41], v[40:41], v[44:45]
    v_pk_add_f32 v[42:43], v[42:43], v[46:47]
    v_pk_mov_b32 v[44:45], v[40:41], v[40:41] op_sel:[0,1]
    v_pk_mov_b32 v[46:47], v[42:43], v[42:43] op_sel:[0,1]
    s_nop 0
    v_permlane32_swap_b32 v40, v44
    v_permlane32_swap_b32 v41, v45
    v_permlane32_swap_b32 v42, v46
    v_permlane32_swap_b32 v43, v47
    v_pk_add_f32 v[40:41], v[40:41], v[44:45]
    v_pk_add_f32 v[42:43], v[42:43], v[46:47]
    v_perm_b32 v36, v40, v43, s40
    v_perm_b32 v37, v41, v43, s41
    v_perm_b32 v38, v42, v43, s42
    s_mov_b64 exec, 0xff
    s_cmp_eq_u32 s38, 0
    s_cbranch_scc1 stg_9
    global_store_dwordx4 v7, v[36:39], s[30:31]
    s_branch std_10
stg_9:
    global_store_dwordx4 v7, v[36:39], s[30:31] sc1
std_10:
    s_branch L_END
L_RELAY:
    s_cmp_lg_u32 s34, 3
    s_cbranch_scc1 L_END
    s_mov_b32 s39, 0
    s_waitcnt vmcnt(0)
    s_branch poll_11_chk
poll_11:
    s_or_b64 exec, s[52:53], 1
    global_load_dwordx4 v[128:131], v14, s[30:31] sc1
    s_or_b64 exec, s[54:55], 1
    global_load_dwordx4 v[132:135], v15, s[30:31] sc1
    s_or_b64 exec, s[56:57], 1
    global_load_dwordx4 v[136:139], v14, s[30:31] offset:-4096 sc1
    s_mov_b64 exec, -1
    s_add_u32 s39, s39, 1
    s_cmp_gt_u32 s39, 262144
    s_cbranch_scc1 L_END
    s_waitcnt vmcnt(0)
poll_11_chk:
    v_cmp_ne_u32 s[52:53], s36, v131
    v_cmp_ne_u32 s[54:55], s36, v135
    v_cmp_ne_u32 s[56:57], s36, v139
    s_or_b64 vcc, s[52:53], s[54:55]
    s_or_b64 vcc, vcc, s[56:57]
    s_cbranch_scc1 poll_11
    v_perm_b32 v131, v129, v128, s43
    v_perm_b32 v135, v133, v132, s43
    v_perm_b32 v139, v137, v136, s43
    v_lshl_or_b32 v131, v130, 24, v131
    v_lshl_or_b32 v135, v134, 24, v135
    v_lshl_or_b32 v139, v138, 24, v139
    v_permlane16_swap_b32 v128, v130
    v_permlane16_swap_b32 v129, v131
    v_permlane16_swap_b32 v132, v134
    v_permlane16_swap_b32 v133, v135
    v_permlane16_swap_b32 v136, v138
    v_permlane16_swap_b32 v137, v139
    v_pk_add_f32 v[128:129], v[128:129], v[130:131]
    v_pk_add_f32 v[132:133], v[132:133], v[134:135]
    v_pk_add_f32 v[136:137], v[136:137], v[138:139]
    v_mov_b32 v130, v128
    v_mov_b32 v131, v129
    v_mov_b32 v134, v132
    v_mov_b32 v135, v133
    v_mov_b32 v138, v136
    v_mov_b32 v139, v137
    v_permlane32_swap_b32 v128, v130
    v_permlane32_swap_b32 v129, v131
    v_permlane32_swap_b32 v132, v134
    v_permlane32_swap_b32 v133, v135
    v_permlane32_swap_b32 v136, v138
    v_permlane32_swap_b32 v137, v139
    v_add_f32 v128, v128, v130
    v_add_f32 v129, v129, v131
    v_add_f32 v132, v132, v134
    v_add_f32 v133, v133, v135
    v_add_f32 v136, v136, v138
    v_add_f32 v137, v137, v139
    v_cvt_pk_bf16_f32 v133, v132, v133
    v_lshlrev_b32 v132, 16, v133
    v_and_b32 v133, 0xffff0000, v133
    v_pk_add_f32 v[132:133], v[132:133], 1.0 op_sel_hi:[1,0]
    s_nop 0
    v_cvt_pk_bf16_f32 v36, v132, v133
    v_cvt_pk_bf16_f32 v37, v128, v129
    v_cvt_pk_bf16_f32 v38, v136, v137
    s_mov_b32 exec_hi, 0
    s_cmp_eq_u32 s38, 0
    s_cbranch_scc1 stg_12
    global_store_dwordx4 v22, v[36:39], s[30:31]
    s_branch std_13
stg_12:
    global_store_dwordx4 v22, v[36:39], s[30:31] sc1
std_13:
    s_branch L_END
L_W2:
    s_mov_b32 s40, 0x07060501
    s_mov_b32 s41, 0x07060502
    s_mov_b32 s42, 0x07060503
    s_mov_b32 s43, 0x0C04000C
    s_and_b32 s46, s44, 0x8
    s_lshl_b32 s46, s46, 8
    s_and_b32 s3, s34, 0x3
    s_lshl_b32 s3, s3, 9
    s_add_u32 s46, s46, s3
    s_and_b32 s3, s34, 0x4
    s_lshl_b32 s3, s3, 5
    s_add_u32 s46, s46, s3
    s_add_u32 s46, s46, 0x30000
    v_and_b32 v28, 7, v0
    v_lshlrev_b32 v28, 4, v28
    v_bfe_u32 v3, v0, 3, 1
    v_lshl_add_u32 v28, v3, 8, v28
    v_lshrrev_b32 v3, 5, v0
    v_lshl_add_u32 v28, v3, 12, v28
    v_bfe_u32 v3, v0, 4, 1
    v_mul_u32_u24 v3, 24576, v3
    v_add_u32 v28, v28, v3
    v_add_u32 v28, s46, v28
    v_add_u32 v29, 49152, v28
    s_bfe_u32 s46, s34, 0x10002
    s_add_u32 s46, s46, 0x8000
    s_bfe_u32 s46, s34, 0x10002
    s_mul_i32 s46, s46, 576
    s_add_u32 s46, s46, 0x8000
    v_and_b32 v17, 511, v16
    v_add_u32 v17, s46, v17
    v_and_b32 v18, 1, v0
    v_mul_u32_u24 v18, 576, v18
    v_lshl_add_u32 v18, v2, 4, v18
    v_add_u32 v18, 0x8000, v18
    v_lshrrev_b32 v3, 2, v1
    v_lshl_add_u32 v4, v2, 3, v3
    v_and_b32 v5, 2, v3
    v_and_b32 v6, 1, v2
    v_lshl_or_b32 v5, v6, 2, v5
    s_and_b32 s46, s34, 0x3
    s_lshl_b32 s46, s46, 1
    v_bfe_u32 v6, v1, 1, 1
    v_add_u32 v6, s46, v6
    v_xor_b32 v5, v5, v6
    v_lshlrev_b32 v5, 4, v5
    v_lshl_or_b32 v5, v4, 7, v5
    v_and_b32 v6, 1, v1
    v_lshl_or_b32 v19, v6, 3, v5
    s_and_b32 s46, s44, 0x8
    s_lshl_b32 s46, s46, 9
    s_and_b32 s3, s44, 0x7
    s_lshl_b32 s3, s3, 8
    s_add_u32 s46, s46, s3
    s_and_b32 s3, s34, 0x3
    s_lshl_b32 s3, s3, 6
    s_add_u32 s46, s46, s3
    s_add_u32 s46, s46, s62
    s_add_u32 s46, s46, 0x14b000
    v_and_b32 v30, 1, v0
    v_lshlrev_b32 v30, 11, v30
    v_lshl_add_u32 v30, v2, 4, v30
    v_add_u32 v30, s46, v30
    s_add_u32 s46, s62, 0x14d000
    v_and_b32 v14, 31, v0
    v_lshlrev_b32 v14, 2, v14
    v_add_u32 v14, s46, v14
    s_waitcnt lgkmcnt(0)
    s_mul_i32 s36, s35, 0x9E3779B1
    s_add_u32 s36, s36, 0x7F4A7C15
    s_lshr_b32 s3, s36, 15
    s_xor_b32 s36, s36, s3
    s_mul_i32 s36, s36, 0x85EBCA6B
    v_mov_b32 v39, s36
    s_add_u32 s63, s36, s37
    s_barrier
    global_load_lds_dwordx4 v22, s[10:11] nt
    s_add_u32 m0, m0, 1024
    s_nop 0
    global_load_lds_dwordx4 v23, s[10:11] nt
    s_add_u32 m0, m0, 1024
    s_waitcnt vmcnt(4)
    v_and_b32 v44, 0xffff0000, v40
    v_lshlrev_b32 v40, 16, v40
    v_and_b32 v45, 0xffff0000, v41
    v_lshlrev_b32 v41, 16, v41
    v_and_b32 v46, 0xffff0000, v42
    v_lshlrev_b32 v42, 16, v42
    v_and_b32 v47, 0xffff0000, v43
    v_lshlrev_b32 v43, 16, v43
    v_pk_add_f32 v[48:49], v[40:41], v[44:45]
    v_pk_add_f32 v[50:51], v[42:43], v[46:47]
    v_pk_add_f32 v[48:49], v[48:49], v[50:51]
    v_add_f32 v56, v48, v49
    s_nop 1
    v_add_f32_dpp v56, v56, v56 quad_perm:[1,0,3,2] row_mask:0xf bank_mask:0xf
    s_nop 1
    v_add_f32_dpp v56, v56, v56 quad_perm:[2,3,0,1] row_mask:0xf bank_mask:0xf
    s_nop 1
    v_add_f32_dpp v56, v56, v56 row_half_mirror row_mask:0xf bank_mask:0xf
    s_nop 1
    v_add_f32_dpp v56, v56, v56 row_mirror row_mask:0xf bank_mask:0xf
    v_mov_b32 v57, v56
    s_nop 1
    v_permlane16_swap_b32 v56, v57
    v_add_f32 v56, v56, v57
    v_mov_b32 v57, v56
    s_nop 1
    v_permlane32_swap_b32 v56, v57
    v_add_f32 v56, v56, v57
    v_mul_f32 v56, 0x3b000000, v56
    v_sub_f32 v40, v40, v56
    v_sub_f32 v41, v41, v56
    v_sub_f32 v42, v42, v56
    v_sub_f32 v43, v43, v56
    v_sub_f32 v44, v44, v56
    v_sub_f32 v45, v45, v56
    v_sub_f32 v46, v46, v56
    v_sub_f32 v47, v47, v56
    v_pk_mul_f32 v[58:59], v[40:41], v[40:41]
    v_pk_fma_f32 v[58:59], v[42:43], v[42:43], v[58:59]
    v_pk_fma_f32 v[58:59], v[44:45], v[44:45], v[58:59]
    v_pk_fma_f32 v[58:59], v[46:47], v[46:47], v[58:59]
    v_add_f32 v58, v58, v59
    s_nop 1
    v_add_f32_dpp v58, v58, v58 quad_perm:[1,0,3,2] row_mask:0xf bank_mask:0xf
    s_nop 1
    v_add_f32_dpp v58, v58, v58 quad_perm:[2,3,0,1] row_mask:0xf bank_mask:0xf
    s_nop 1
    v_add_f32_dpp v58, v58, v58 row_half_mirror row_mask:0xf bank_mask:0xf
    s_nop 1
    v_add_f32_dpp v58, v58, v58 row_mirror row_mask:0xf bank_mask:0xf
    v_mov_b32 v57, v58
    s_nop 1
    v_permlane16_swap_b32 v58, v57
    v_add_f32 v58, v58, v57
    v_mov_b32 v57, v58
    s_nop 1
    v_permlane32_swap_b32 v58, v57
    v_add_f32 v58, v58, v57
    v_mul_f32 v58, 0x3b000000, v58
    v_cvt_pk_bf16_f32 v56, v56, v56
    v_and_b32 v56, 0xffff0000, v56
    v_cvt_pk_bf16_f32 v58, v58, v58
    v_and_b32 v58, 0xffff0000, v58
    v_add_f32 v58, 0x3727c5ac, v58
    v_cvt_pk_bf16_f32 v58, v58, v58
    v_and_b32 v58, 0xffff0000, v58
    v_sqrt_f32 v58, v58
    s_nop 0
    v_cvt_pk_bf16_f32 v58, v58, v58
    v_and_b32 v58, 0xffff0000, v58
    v_rcp_f32 v58, v58
    v_and_b32 v26, 0xffff0000, v26
    v_sub_f32 v26, v26, v56
    v_cvt_pk_bf16_f32 v26, v26, v26
    v_and_b32 v26, 0xffff0000, v26
    v_mul_f32 v26, v26, v58
    v_cvt_pk_bf16_f32 v26, v26, v26
    v_and_b32 v26, 0xffff0000, v26
    s_waitcnt vmcnt(1)
    global_load_dword v15, v14, s[30:31] sc1
    global_load_dwordx4 v[64:67], v28, s[30:31] sc1
    global_load_dwordx4 v[68:71], v29, s[30:31] sc1
    s_waitcnt vmcnt(3)
    s_barrier
    s_cmp_ge_u32 s34, 4
    s_cbranch_scc1 L_NOWQ
    ds_read_b64_tr_b16 v[100:101], v19 offset:0
    ds_read_b64_tr_b16 v[102:103], v19 offset:512
    ds_read_b64_tr_b16 v[104:105], v19 offset:4096
    ds_read_b64_tr_b16 v[106:107], v19 offset:4608
    ds_read_b64_tr_b16 v[108:109], v19 offset:8192
    ds_read_b64_tr_b16 v[110:111], v19 offset:8704
    ds_read_b64_tr_b16 v[112:113], v19 offset:12288
    ds_read_b64_tr_b16 v[114:115], v19 offset:12800
    ds_read_b64_tr_b16 v[116:117], v19 offset:16384
    ds_read_b64_tr_b16 v[118:119], v19 offset:16896
    ds_read_b64_tr_b16 v[120:121], v19 offset:20480
    ds_read_b64_tr_b16 v[122:123], v19 offset:20992
    ds_read_b64_tr_b16 v[124:125], v19 offset:24576
    ds_read_b64_tr_b16 v[126:127], v19 offset:25088
    ds_read_b64_tr_b16 v[128:129], v19 offset:28672
    ds_read_b64_tr_b16 v[130:131], v19 offset:29184
L_NOWQ:
    s_mov_b32 s39, 0
    s_waitcnt vmcnt(0)
    s_branch poll_14_chk
poll_14:
    s_sleep 2
    s_or_b64 exec, s[52:53], 1
    global_load_dwordx4 v[64:67], v28, s[30:31] sc1
    s_or_b64 exec, s[54:55], 1
    global_load_dwordx4 v[68:71], v29, s[30:31] sc1
    s_mov_b64 exec, -1
    s_add_u32 s39, s39, 1
    s_cmp_gt_u32 s39, 262144
    s_cbranch_scc1 L_END
    s_waitcnt vmcnt(0)
poll_14_chk:
    v_cmp_ne_u32 s[52:53], s36, v67
    v_cmp_ne_u32 s[54:55], s36, v71
    s_or_b64 vcc, s[52:53], s[54:55]
    s_cbranch_scc1 poll_14
    v_perm_b32 v67, v65, v64, s43
    v_perm_b32 v71, v69, v68, s43
    v_lshl_or_b32 v67, v66, 24, v67
    v_lshl_or_b32 v71, v70, 24, v71
    v_pk_add_f32 v[64:65], v[64:65], v[68:69]
    v_pk_add_f32 v[66:67], v[66:67], v[70:71]
    s_nop 1
    v_permlane16_swap_b32 v64, v66
    v_permlane16_swap_b32 v65, v67
    v_pk_add_f32 v[64:65], v[64:65], v[66:67]
    s_nop 1
    v_permlane32_swap_b32 v64, v65
    v_cvt_pk_bf16_f32 v65, v64, v65
    v_lshlrev_b32 v64, 16, v65
    v_and_b32 v65, 0xffff0000, v65
    v_add_f32 v65, 1.0, v65
    v_cvt_pk_bf16_f32 v65, v65, v65
    v_and_b32 v65, 0xffff0000, v65
    v_mul_f32 v65, v65, v26
    v_cvt_pk_bf16_f32 v65, v65, v65
    v_and_b32 v65, 0xffff0000, v65
    v_add_f32 v64, v64, v65
    v_cvt_pk_bf16_f32 v64, v64, v64
    ds_write_b16 v17, v64
    v_cmp_ne_u32 vcc, s63, v15
    s_cmp_eq_u64 vcc, 0
    s_cselect_b32 s38, 1, 0
    s_cbranch_scc1 L_LOCOK
    global_load_dword v15, v14, s[30:31] sc1
    s_waitcnt vmcnt(0)
    v_cmp_ne_u32 vcc, s63, v15
    s_cmp_eq_u64 vcc, 0
    s_cselect_b32 s38, 1, 0
L_LOCOK:
    s_waitcnt lgkmcnt(0)
    s_barrier
    s_cmp_ge_u32 s34, 4
    s_cbranch_scc1 L_QDONE
    ds_read_b128 v[40:43], v18 offset:0
    ds_read_b128 v[44:47], v18 offset:64
    ds_read_b128 v[48:51], v18 offset:128
    ds_read_b128 v[52:55], v18 offset:192
    ds_read_b128 v[56:59], v18 offset:256
    ds_read_b128 v[60:63], v18 offset:320
    ds_read_b128 v[64:67], v18 offset:384
    ds_read_b128 v[68:71], v18 offset:448
    s_waitcnt lgkmcnt(7)
    v_mfma_f32_16x16x32_bf16 v[96:99], v[100:103], v[40:43], 0
    s_waitcnt lgkmcnt(6)
    v_mfma_f32_16x16x32_bf16 v[96:99], v[104:107], v[44:47], v[96:99]
    s_waitcnt lgkmcnt(5)
    v_mfma_f32_16x16x32_bf16 v[96:99], v[108:111], v[48:51], v[96:99]
    s_waitcnt lgkmcnt(4)
    v_mfma_f32_16x16x32_bf16 v[96:99], v[112:115], v[52:55], v[96:99]
    s_waitcnt lgkmcnt(3)
    v_mfma_f32_16x16x32_bf16 v[96:99], v[116:119], v[56:59], v[96:99]
    s_waitcnt lgkmcnt(2)
    v_mfma_f32_16x16x32_bf16 v[96:99], v[120:123], v[60:63], v[96:99]
    s_waitcnt lgkmcnt(1)
    v_mfma_f32_16x16x32_bf16 v[96:99], v[124:127], v[64:67], v[96:99]
    s_waitcnt lgkmcnt(0)
    v_mfma_f32_16x16x32_bf16 v[96:99], v[128:131], v[68:71], v[96:99]
    s_nop 7
    v_perm_b32 v36, v96, v99, s40
    v_perm_b32 v37, v97, v99, s41
    v_perm_b32 v38, v98, v99, s42
    s_mov_b32 exec_lo, 0x00030003
    s_mov_b32 exec_hi, 0x00030003
    s_cmp_eq_u32 s38, 0
    s_cbranch_scc1 stg_15
    global_store_dwordx4 v30, v[36:39], s[30:31]
    s_branch std_16
stg_15:
    global_store_dwordx4 v30, v[36:39], s[30:31] sc1
std_16:
    s_mov_b64 exec, -1
L_QDONE:
    s_mul_i32 s48, s32, 14
    s_add_u32 s48, s48, s44
    s_and_b32 s46, s32, 0x1
    s_lshl_b32 s46, s46, 4
    s_cmp_ge_u32 s44, 14
    s_cselect_b32 s46, s46, 0
    s_sub_u32 s48, s48, s46
    s_and_b32 s51, s48, 0x3
    s_lshl_b32 s51, s51, 2
    s_and_b32 s3, s34, 0x3
    s_add_u32 s51, s51, s3
    s_lshl_b32 s46, s48, 5
    v_lshrrev_b32 v17, 1, v0
    v_mul_u32_u24 v17, 3584, v17
    v_and_b32 v3, 1, v0
    v_lshl_add_u32 v17, v3, 4, v17
    v_add_u32 v17, s46, v17
    s_and_b32 s50, s34, 0x4
    s_lshl_b32 s50, s50, 1
    s_add_u32 s50, s50, s51
    s_add_u32 s50, s50, 0x4
    s_and_b32 s50, s50, 15
    s_add_u32 s47, s50, 4
    s_and_b32 s47, s47, 15
    s_mul_i32 s46, s51, 114688
    v_add_u32 v5, s46, v17
    s_mul_i32 s46, s50, 114688
    v_add_u32 v6, s46, v17
    s_mul_i32 s46, s47, 114688
    v_add_u32 v7, s46, v17
    s_lshl_b32 s46, s32, 19
    s_lshl_b32 s3, s44, 15
    s_add_u32 s46, s46, s3
    s_and_b32 s3, s34, 0x3
    s_lshl_b32 s3, s3, 13
    s_add_u32 s46, s46, s3
    v_lshlrev_b32 v27, 7, v0
    v_add_u32 v27, s46, v27
    s_lshl_b32 s46, s51, 10
    s_add_u32 s46, s46, 0x21000
    s_mov_b32 m0, s46
    s_barrier
    s_barrier
    s_cmp_ge_u32 s34, 4
    s_cbranch_scc1 L_E5
    s_barrier
    global_load_lds_dwordx4 v5, s[16:17]
    s_cmp_ge_u32 s44, 14
    s_cbranch_scc1 L_END
    s_lshl_b32 s46, s50, 10
    s_add_u32 s46, s46, 0x21000
    s_mov_b32 m0, s46
    s_waitcnt vmcnt(0)
    global_load_lds_dwordx4 v6, s[16:17]
    s_lshl_b32 s46, s47, 10
    s_add_u32 s46, s46, 0x21000
    s_mov_b32 m0, s46
    s_nop 0
    global_load_lds_dwordx4 v7, s[16:17]
    s_waitcnt vmcnt(0)
    s_barrier
    s_branch L_END
L_E5:
    global_load_dword v161, v27, s[12:13]
    s_cmp_ge_u32 s44, 14
    s_cbranch_scc1 L_END
    s_lshl_b32 s46, s48, 14
    s_and_b32 s3, s34, 0x3
    s_lshl_b32 s3, s3, 8
    s_add_u32 s46, s46, s3
    v_lshlrev_b32 v9, 12, v2
    v_lshl_add_u32 v9, v1, 4, v9
    v_add_u32 v9, s46, v9
    s_and_b32 s46, s34, 0x3
    s_lshl_b32 s46, s46, 8
    v_and_b32 v8, 31, v0
    v_lshlrev_b32 v8, 3, v8
    v_lshrrev_b32 v3, 5, v0
    v_lshl_add_u32 v8, v3, 10, v8
    v_add_u32 v8, s46, v8
    s_and_b32 s46, s34, 0x3
    s_lshl_b32 s46, s46, 9
    s_add_u32 s46, s46, s62
    s_add_u32 s46, s46, 0x148800
    v_and_b32 v12, 31, v0
    v_lshlrev_b32 v12, 4, v12
    v_lshrrev_b32 v3, 5, v0
    v_lshl_add_u32 v12, v3, 11, v12
    v_add_u32 v12, s46, v12
    v_add_u32 v14, 6144, v12
    s_lshl_b32 s46, s48, 5
    v_and_b32 v13, 3, v0
    v_lshlrev_b32 v13, 1, v13
    v_lshl_add_u32 v13, v2, 3, v13
    v_add_u32 v13, s46, v13
    s_lshl_b32 s46, s50, 10
    s_add_u32 s46, s46, 0x21000
    s_mov_b32 m0, s46
    v_and_b32 v94, 1, v0
    v_lshlrev_b32 v94, 4, v94
    v_mov_b32 v95, 0xffff
    v_lshlrev_b32 v95, v94, v95
    s_mov_b32 vcc_lo, 0x3030303
    s_mov_b32 vcc_hi, 0x3030303
    v_cndmask_b32 v90, 0, v95, vcc
    s_mov_b32 vcc_lo, 0xc0c0c0c
    s_mov_b32 vcc_hi, 0xc0c0c0c
    v_cndmask_b32 v91, 0, v95, vcc
    s_mov_b32 vcc_lo, 0x30303030
    s_mov_b32 vcc_hi, 0x30303030
    v_cndmask_b32 v92, 0, v95, vcc
    s_mov_b32 vcc_lo, 0xc0c0c0c0
    s_mov_b32 vcc_hi, 0xc0c0c0c0
    v_cndmask_b32 v93, 0, v95, vcc
    s_and_b32 s46, s34, 0x3
    s_mul_i32 s46, s46, 2912
    s_add_u32 s46, s46, 0x4000
    v_and_b32 v18, 31, v0
    v_lshlrev_b32 v18, 3, v18
    v_lshrrev_b32 v3, 5, v0
    v_mul_u32_u24 v3, 1456, v3
    v_add_u32 v18, v18, v3
    v_add_u32 v18, s46, v18
    v_lshlrev_b32 v19, 4, v2
    v_bfe_u32 v3, v0, 3, 1
    v_mul_u32_u24 v3, 1456, v3
    v_add_u32 v19, v19, v3
    v_add_u32 v19, s46, v19
    v_and_b32 v3, 7, v1
    v_cmp_lt_u32 vcc, 4, v3
    s_nop 1
    v_cndmask_b32 v3, v3, 3, vcc
    v_mul_u32_u24 v3, 288, v3
    v_add_u32 v19, v19, v3
    s_and_b32 s46, s34, 0x3
    s_lshl_b32 s46, s46, 12
    s_add_u32 s46, s46, 0x21000
    v_bfe_u32 v20, v0, 2, 2
    v_lshlrev_b32 v20, 5, v20
    v_lshl_add_u32 v20, v2, 8, v20
    v_and_b32 v3, 3, v0
    v_lshl_add_u32 v20, v3, 3, v20
    v_add_u32 v20, s46, v20
    s_and_b32 s46, s34, 0x3
    s_lshl_b32 s46, s46, 2
    s_add_u32 s46, s46, 0x6d80
    v_lshlrev_b32 v21, 4, v0
    v_add_u32 v21, s46, v21
    s_and_b32 s46, s34, 0x3
    s_lshl_b32 s46, s46, 8
    s_add_u32 s46, s46, 0x79c0
    v_lshlrev_b32 v25, 4, v1
    v_lshrrev_b32 v3, 5, v0
    v_mul_u32_u24 v3, 1088, v3
    v_add_u32 v25, v25, v3
    v_add_u32 v25, s46, v25
    v_and_b32 v23, 3, v0
    v_lshlrev_b32 v23, 4, v23
    v_bfe_u32 v3, v0, 3, 1
    v_mul_u32_u24 v3, 640, v3
    v_add_u32 v23, v23, v3
    v_add_u32 v23, 0x6d80, v23
    v_bfe_u32 v15, v0, 1, 1
    v_mul_u32_u24 v15, 1728, v15
    v_add_u32 v15, 0x140, v15
    v_add_u32 v15, v15, v23
    v_and_b32 v22, 3, v0
    v_lshlrev_b32 v22, 4, v22
    v_lshl_add_u32 v22, v2, 6, v22
    v_bfe_u32 v3, v0, 3, 1
    v_mul_u32_u24 v3, 1088, v3
    v_add_u32 v22, v22, v3
    v_add_u32 v22, 0x79c0, v22
    v_mov_b32 v80, 0x3b000000
    v_mov_b32 v81, 0x3727c5ac
    v_mov_b32 v82, 0xbdd2d3e8
    v_mov_b32 v83, 0xc0135761
    s_and_b32 s46, s48, 0x1
    s_lshl_b32 s46, s46, 12
    s_lshr_b32 s3, s48, 1
    s_lshl_b32 s3, s3, 14
    s_add_u32 s46, s46, s3
    s_and_b32 s3, s34, 0x3
    s_lshl_b32 s3, s3, 10
    s_add_u32 s46, s46, s3
    s_add_u32 s46, s46, 0x50000
    v_lshlrev_b32 v24, 4, v0
    v_add_u32 v24, s46, v24
    s_and_b32 s46, s34, 0x3
    s_lshl_b32 s46, s46, 8
    s_add_u32 s46, s46, 0x1000
    v_lshrrev_b32 v26, 5, v0
    v_lshlrev_b32 v26, 7, v26
    v_add_u32 v26, s46, v26
    s_lshl_b32 s46, s44, 4
    s_and_b32 s3, s34, 0x3
    s_lshl_b32 s3, s3, 2
    s_add_u32 s46, s46, s3
    s_add_u32 s46, s46, s62
    s_add_u32 s46, s46, 0x14d200
    v_mov_b32 v27, s46
    v_mov_b32 v4, 0x3f803f80
    v_mov_b32 v5, 0x3f803f80
    ds_write_b64 v18, v[4:5] offset:864
    s_barrier
    global_load_dwordx4 v[140:143], v9, s[20:21] offset:0 nt
    global_load_dwordx4 v[144:147], v9, s[20:21] offset:1024 nt
    global_load_dwordx4 v[148:151], v9, s[20:21] offset:2048 nt
    global_load_dwordx4 v[152:155], v9, s[20:21] offset:3072 nt
    global_load_dwordx2 v[10:11], v8, s[4:5]
    global_load_short_d16_hi v88, v13, s[18:19]
    s_waitcnt vmcnt(0)
    global_load_lds_dwordx4 v6, s[16:17]
    s_waitcnt vmcnt(0)
    s_barrier
    ds_read_b64_tr_b16 v[104:105], v20 offset:0
    ds_read_b64_tr_b16 v[106:107], v20 offset:128
    ds_read_b64_tr_b16 v[108:109], v20 offset:1024
    ds_read_b64_tr_b16 v[110:111], v20 offset:1152
    ds_read_b64_tr_b16 v[112:113], v20 offset:2048
    ds_read_b64_tr_b16 v[114:115], v20 offset:2176
    ds_read_b64_tr_b16 v[116:117], v20 offset:3072
    ds_read_b64_tr_b16 v[118:119], v20 offset:3200
    s_waitcnt vmcnt(0)
    v_lshlrev_b32 v28, 16, v10
    v_and_b32 v29, 0xffff0000, v10
    v_lshlrev_b32 v30, 16, v11
    v_and_b32 v31, 0xffff0000, v11
    v_and_b32 v88, 0xffff0000, v88
    s_mov_b32 s39, 0
    s_mov_b64 s[52:53], -1
    s_mov_b64 s[54:55], -1
    s_mov_b64 s[56:57], -1
poll_17:
    s_or_b64 exec, s[52:53], 1
    global_load_dwordx4 v[40:43], v12, s[30:31] offset:-2048 sc1
    s_or_b64 exec, s[54:55], 1
    global_load_dwordx4 v[44:47], v12, s[30:31] offset:2048 sc1
    s_or_b64 exec, s[56:57], 1
    global_load_dwordx4 v[48:51], v26, s[30:31] sc1
    s_mov_b64 exec, -1
    s_add_u32 s39, s39, 1
    s_cmp_gt_u32 s39, 262144
    s_cbranch_scc1 L_END
    s_waitcnt vmcnt(0)
    v_cmp_ne_u32 s[52:53], s36, v43
    v_cmp_ne_u32 s[54:55], s36, v47
    v_cmp_ne_u32 s[56:57], s36, v51
    s_or_b64 vcc, s[52:53], s[54:55]
    s_or_b64 vcc, vcc, s[56:57]
    s_cbranch_scc1 poll_17
    v_add_u32 v24, v48, v24
    s_waitcnt lgkmcnt(0)
    ds_write2_b32 v18, v40, v44 offset0:72 offset1:73
    ds_write2_b32 v18, v41, v45 offset0:144 offset1:145
    v_lshlrev_b32 v32, 16, v40
    v_and_b32 v33, 0xffff0000, v40
    v_lshlrev_b32 v34, 16, v44
    v_and_b32 v35, 0xffff0000, v44
    v_lshlrev_b32 v84, 16, v42
    v_and_b32 v85, 0xffff0000, v42
    v_lshlrev_b32 v86, 16, v46
    v_and_b32 v87, 0xffff0000, v46
    s_waitcnt lgkmcnt(0)
    s_mov_b32 s39, 0
    s_mov_b64 s[52:53], -1
poll_18:
    s_mov_b64 exec, s[52:53]
    global_load_dwordx4 v[40:43], v14, s[30:31] sc1
    s_mov_b64 exec, -1
    s_add_u32 s39, s39, 1
    s_cmp_gt_u32 s39, 262144
    s_cbranch_scc1 L_END
    s_waitcnt vmcnt(0)
    v_cmp_ne_u32 s[52:53], s36, v43
    s_cmp_lg_u64 s[52:53], 0
    s_cbranch_scc1 poll_18
    v_pk_fma_f32 v[28:29], v[84:85], v[40:41], v[28:29]
    v_perm_b32 v43, v41, v40, s43
    v_lshl_or_b32 v43, v42, 24, v43
    v_pk_fma_f32 v[30:31], v[86:87], v[42:43], v[30:31]
    v_pk_mul_f32 v[32:33], v[32:33], v[28:29]
    v_pk_mul_f32 v[34:35], v[34:35], v[30:31]
    v_cvt_pk_bf16_f32 v4, v28, v29
    v_cvt_pk_bf16_f32 v5, v30, v31
    v_cvt_pk_bf16_f32 v6, v32, v33
    v_cvt_pk_bf16_f32 v7, v34, v35
    ds_write_b64 v18, v[4:5] offset:1152
    ds_write_b64 v18, v[6:7]
    ds_read_b128 v[40:43], v19 offset:0
    ds_read_b128 v[44:47], v19 offset:64
    ds_read_b128 v[48:51], v19 offset:128
    ds_read_b128 v[52:55], v19 offset:192
    s_waitcnt lgkmcnt(3)
    v_mfma_f32_16x16x32_bf16 v[100:103], v[40:43], v[40:43], 0
    v_mfma_f32_16x16x32_bf16 v[96:99], v[40:43], v[104:107], 0
    s_waitcnt lgkmcnt(2)
    v_mfma_f32_16x16x32_bf16 v[100:103], v[44:47], v[44:47], v[100:103]
    v_mfma_f32_16x16x32_bf16 v[96:99], v[44:47], v[108:111], v[96:99]
    s_waitcnt lgkmcnt(1)
    v_mfma_f32_16x16x32_bf16 v[100:103], v[48:51], v[48:51], v[100:103]
    v_mfma_f32_16x16x32_bf16 v[96:99], v[48:51], v[112:115], v[96:99]
    s_waitcnt lgkmcnt(0)
    v_mfma_f32_16x16x32_bf16 v[100:103], v[52:55], v[52:55], v[100:103]
    v_mfma_f32_16x16x32_bf16 v[96:99], v[52:55], v[116:119], v[96:99]
    s_mov_b32 exec_lo, 0x0030000f
    s_mov_b32 exec_hi, 0x30000f00
    s_nop 4
    ds_write2st64_b32 v21, v100, v101 offset1:4
    ds_write_b32 v21, v102 offset:2048
    s_mov_b32 exec_lo, 0xffff
    s_mov_b32 exec_hi, 0xffff
    ds_write_b128 v25, v[96:99]
    s_mov_b64 exec, -1
    s_waitcnt lgkmcnt(0)
    s_barrier
    ds_read_b128 v[40:43], v15
    ds_read_b128 v[44:47], v23
    ds_read_b128 v[48:51], v23 offset:1024
    ds_read_b128 v[64:67], v22 offset:0
    ds_read_b128 v[68:71], v22 offset:256
    ds_read_b128 v[72:75], v22 offset:512
    ds_read_b128 v[76:79], v22 offset:768
    s_waitcnt lgkmcnt(6)
    v_pk_add_f32 v[40:41], v[40:41], v[42:43]
    v_add_f32 v40, v40, v41
    s_waitcnt lgkmcnt(4)
    v_pk_add_f32 v[44:45], v[44:45], v[46:47]
    v_pk_add_f32 v[48:49], v[48:49], v[50:51]
    v_mul_f32_dpp v52, v40, v80 quad_perm:[1,1,1,1] row_mask:0xf bank_mask:0xf
    v_mul_f32_dpp v53, v40, v80 quad_perm:[0,0,0,0] row_mask:0xf bank_mask:0xf
    v_add_f32 v44, v44, v45
    v_add_f32 v48, v48, v49
    v_add_f32 v53, v53, v81
    v_fma_f32 v44, -v52, v48, v44
    v_fma_f32 v53, -v52, v52, v53
    v_rsq_f32 v53, v53
    s_waitcnt lgkmcnt(0)
    v_mul_f32_dpp v54, v44, v52 quad_perm:[1,1,1,1] row_mask:0xf bank_mask:0xf
    v_pk_add_f32 v[64:65], v[64:65], v[68:69]
    v_pk_add_f32 v[66:67], v[66:67], v[70:71]
    v_mul_f32_dpp v55, v44, v53 quad_perm:[3,3,3,3] row_mask:0xf bank_mask:0xf
    v_mul_f32_dpp v56, v44, v53 quad_perm:[2,2,2,2] row_mask:0xf bank_mask:0xf
    v_sub_f32_dpp v54, v44, v54 quad_perm:[0,0,0,0] row_mask:0xf bank_mask:0xf
    v_pk_add_f32 v[72:73], v[72:73], v[76:77]
    v_pk_add_f32 v[74:75], v[74:75], v[78:79]
    v_add_f32_dpp v55, v40, v55 quad_perm:[3,3,3,3] row_mask:0xf bank_mask:0xf
    v_add_f32_dpp v57, v40, v56 quad_perm:[2,2,2,2] row_mask:0xf bank_mask:0xf
    v_mul_f32 v54, v53, v54
    v_mul_f32 v55, v80, v55
    v_add_f32 v57, v57, v56
    v_pk_add_f32 v[64:65], v[64:65], v[72:73]
    v_pk_add_f32 v[66:67], v[66:67], v[74:75]
    v_fma_f32 v57, v53, v54, v57
    v_fma_f32 v57, v57, v80, v81
    v_fma_f32 v57, -v55, v55, v57
    v_rsq_f32 v48, v57
    v_fma_f32 v64, -v52, v65, v64
    v_fma_f32 v66, -v55, v67, v66
    v_fma_f32 v64, v53, v64, v66
    v_fma_f32 v64, v48, v64, v88
    v_mul_f32 v65, v64, v64
    v_fma_f32 v65, v65, v82, v83
    v_mul_f32 v65, v65, v64
    v_exp_f32 v65, v65
    s_nop 0
    v_add_f32 v65, 1.0, v65
    v_rcp_f32 v65, v65
    s_nop 0
    v_mul_f32 v64, v64, v65
    v_cvt_pk_bf16_f32 v64, v64, v64
    s_nop 1
    v_and_b32_dpp v40, v64, v90 quad_perm:[0,0,0,0] row_mask:0xf bank_mask:0xf
    v_and_b32_dpp v41, v64, v91 quad_perm:[0,0,0,0] row_mask:0xf bank_mask:0xf
    v_and_b32_dpp v42, v64, v92 quad_perm:[0,0,0,0] row_mask:0xf bank_mask:0xf
    v_and_b32_dpp v43, v64, v93 quad_perm:[0,0,0,0] row_mask:0xf bank_mask:0xf
    v_and_b32_dpp v44, v64, v90 quad_perm:[1,1,1,1] row_mask:0xf bank_mask:0xf
    v_and_b32_dpp v45, v64, v91 quad_perm:[1,1,1,1] row_mask:0xf bank_mask:0xf
    v_and_b32_dpp v46, v64, v92 quad_perm:[1,1,1,1] row_mask:0xf bank_mask:0xf
    v_and_b32_dpp v47, v64, v93 quad_perm:[1,1,1,1] row_mask:0xf bank_mask:0xf
    v_mfma_f32_16x16x32_bf16 v[96:99], v[40:43], v[140:143], 0
    v_and_b32_dpp v48, v64, v90 quad_perm:[2,2,2,2] row_mask:0xf bank_mask:0xf
    v_and_b32_dpp v49, v64, v91 quad_perm:[2,2,2,2] row_mask:0xf bank_mask:0xf
    v_and_b32_dpp v50, v64, v92 quad_perm:[2,2,2,2] row_mask:0xf bank_mask:0xf
    v_and_b32_dpp v51, v64, v93 quad_perm:[2,2,2,2] row_mask:0xf bank_mask:0xf
    v_mfma_f32_16x16x32_bf16 v[96:99], v[44:47], v[144:147], v[96:99]
    v_and_b32_dpp v52, v64, v90 quad_perm:[3,3,3,3] row_mask:0xf bank_mask:0xf
    v_and_b32_dpp v53, v64, v91 quad_perm:[3,3,3,3] row_mask:0xf bank_mask:0xf
    v_and_b32_dpp v54, v64, v92 quad_perm:[3,3,3,3] row_mask:0xf bank_mask:0xf
    v_and_b32_dpp v55, v64, v93 quad_perm:[3,3,3,3] row_mask:0xf bank_mask:0xf
    v_mfma_f32_16x16x32_bf16 v[96:99], v[48:51], v[148:151], v[96:99]
    s_nop 0
    v_mfma_f32_16x16x32_bf16 v[96:99], v[52:55], v[152:155], v[96:99]
    s_nop 7
    v_perm_b32 v36, v96, v99, s40
    v_perm_b32 v37, v97, v99, s41
    v_perm_b32 v38, v98, v99, s42
    global_store_dwordx4 v24, v[36:39], s[30:31] sc1
    s_mov_b64 exec, 1
    global_store_dword v27, v39, s[30:31]
    s_mov_b64 exec, -1
L_END:
L_EXIT:
    s_endpgm
.section .rodata,"a"
.p2align 6
.amdhsa_kernel adaLN_cond__sliding_block_cached__mixer_channel_mlp__decode_kernel
  .amdhsa_next_free_vgpr 168
  .amdhsa_next_free_sgpr 96
  .amdhsa_accum_offset 168
  .amdhsa_group_segment_fixed_size 0
  .amdhsa_kernarg_size 120
  .amdhsa_user_sgpr_count 2
  .amdhsa_user_sgpr_kernarg_segment_ptr 1
  .amdhsa_system_sgpr_workgroup_id_x 1
  .amdhsa_float_denorm_mode_32 3
.end_amdhsa_kernel
```
